```python
import torch

def _softmax(x, axis=-1):
    return torch.softmax(x, dim=axis)
def _gelu(x):
    return torch.nn.functional.gelu(x, approximate="tanh")
def _silu(x):
    return torch.nn.functional.silu(x)
def _sigmoid(x):
    return torch.sigmoid(x)
def _layernorm(x, axis=-1, eps=1e-5):
    m = x.mean(dim=axis, keepdim=True)
    v = x.var(dim=axis, keepdim=True, unbiased=False)
    return (x - m) / torch.sqrt(v + eps)
def _scatter_add(tgt, idx, src, axis=0):
    return tgt.clone().index_add_(axis, idx, src)
def _segment_sum(src, seg, n):
    out = torch.zeros((n,) + src.shape[1:], dtype=src.dtype)
    return out.index_add_(0, seg, src)
def _pad(x, pw):
    flat = tuple(v for pair in reversed(pw) for v in pair)
    return torch.nn.functional.pad(x, flat)

kernel_name = 'standalone__mha_softmax__near_ridge'

def setup_inputs():

    _w = (lambda a: (lambda t: t.to(torch.bfloat16) if t.is_floating_point() else t)(torch.as_tensor(a)))
    B, H, Sq, Sk, D = 8, 32, 384, 384, 128
    return {
        "q": _w((lambda *s: torch.randn(*s, dtype=torch.bfloat16) * 0.8)(B, H, Sq, D)),
        "k": _w((lambda *s: torch.randn(*s, dtype=torch.bfloat16) * 0.8)(B, H, Sk, D)),
        "v": _w((lambda *s: torch.randn(*s, dtype=torch.bfloat16) * 0.05)(B, H, Sk, D)),
    }

def reference(q, k, v):
    scale = q.shape[-1] ** -0.5
    scores = torch.einsum("bhqd,bhkd->bhqk", q, k) * scale
    p = _softmax(scores, axis=-1)
    return torch.einsum("bhqk,bhkd->bhqd", p, v)
```

```asm
; @launch grid=(256,1,1) block=(256,1,1) lds=163840
.amdgcn_target "amdgcn-amd-amdhsa--gfx950"
.text
.globl standalone__mha_softmax__near_ridge_kernel
.p2align 12
.p2align 8
.type standalone__mha_softmax__near_ridge_kernel,@function
standalone__mha_softmax__near_ridge_kernel:
    s_cmp_ge_u32 s2, 256
    s_cbranch_scc1 L_end
    s_load_dwordx4 s[4:7], s[0:1], 0
    s_load_dwordx4 s[8:11], s[0:1], 16
    v_lshrrev_b32 v1, 6, v0
    v_and_b32 v2, 63, v0
    v_readfirstlane_b32 s12, v1
    s_getpc_b64 s[94:95]
    s_bfe_u32 s3, s2, 0x30003
    s_lshl_b32 s3, s3, 12
    v_lshl_add_u32 v250, v0, 4, s3
    global_load_dword v248, v250, s[94:95]
    v_lshrrev_b32 v4, 4, v2
    v_bfe_u32 v5, v2, 2, 2
    v_and_b32 v6, 3, v2
    v_and_b32 v7, 1, v1
    v_lshlrev_b32 v7, 1, v7
    v_xor_b32 v8, v6, v7
    v_lshlrev_b32 v8, 4, v8
    v_lshl_add_u32 v8, v4, 6, v8
    v_lshl_add_u32 v8, v5, 8, v8
    v_lshl_add_u32 v244, v1, 11, v8
    s_mul_i32 s3, s2, 98304
    s_mov_b32 s33, 0
    s_mul_i32 s13, s12, 40960
    s_lshl_b32 s35, s12, 11
    s_add_u32 s35, s35, s33
    s_and_b32 s92, s12, 1
    s_lshl3_add_u32 s92, s92, s13
    s_mov_b32 s19, 0x20000
    s_mov_b32 s23, 0x20000
    s_mov_b32 s27, 0x20000
    s_mov_b32 s31, 0x20000
    s_sub_u32 s18, 98304, s35
    s_mov_b32 s22, 98304
    s_mov_b32 s26, 100352
    s_sub_u32 s30, 98304, s33
    s_add_u32 s35, s35, s3
    s_add_u32 s33, s33, s3
    s_waitcnt lgkmcnt(0)
    s_add_u32 s16, s4, s35
    s_addc_u32 s17, s5, 0
    s_add_u32 s20, s6, s3
    s_addc_u32 s21, s7, 0
    s_add_u32 s24, s8, s3
    s_addc_u32 s25, s9, 0
    s_sub_u32 s24, s24, 2048
    s_subb_u32 s25, s25, 0
    s_add_u32 m0, s13, 0
    s_mov_b32 s14, 49152
    buffer_load_dwordx4 v244, s[16:19], s14 offen offset:0 nt lds
    buffer_load_dwordx4 v244, s[16:19], s14 offen offset:1024 nt lds
    buffer_load_dwordx4 v244, s[16:19], s14 offen offset:2048 nt lds
    buffer_load_dwordx4 v244, s[16:19], s14 offen offset:3072 nt lds
    s_add_u32 m0, s13, 4112
    s_mov_b32 s14, 0
    buffer_load_dwordx4 v244, s[20:23], s14 offen offset:0 nt lds
    buffer_load_dwordx4 v244, s[20:23], s14 offen offset:1024 nt lds
    s_add_u32 m0, s92, 4112
    s_nop 0
    buffer_load_dwordx4 v244, s[24:27], s14 offen offset:2048 nt lds
    buffer_load_dwordx4 v244, s[24:27], s14 offen offset:3072 nt lds
    s_add_u32 s28, s10, s33
    s_addc_u32 s29, s11, 0
    v_and_b32 v9, 1, v5
    v_lshlrev_b32 v9, 1, v9
    v_xor_b32 v9, v4, v9
    v_lshlrev_b32 v9, 4, v9
    v_lshl_add_u32 v9, v6, 6, v9
    v_mul_u32_u24 v10, 0xa000, v5
    v_add_u32 v240, v10, v9
    v_xor_b32 v9, v4, v7
    v_lshlrev_b32 v9, 4, v9
    v_lshl_add_u32 v9, v6, 6, v9
    v_lshl_add_u32 v9, v5, 10, v9
    v_add_u32 v243, s13, v9
    v_and_b32 v9, 1, v4
    v_lshlrev_b32 v9, 1, v9
    v_xor_b32 v9, v6, v9
    v_lshlrev_b32 v9, 4, v9
    v_lshl_add_u32 v9, v5, 6, v9
    v_and_b32 v10, 1, v4
    v_lshl_add_u32 v9, v10, 3, v9
    v_mul_u32_u24 v10, 0xa000, v4
    v_add_u32 v9, v10, v9
    v_add_u32 v241, 0x800, v9
    v_xor_b32 v242, 32, v241
    v_lshlrev_b32 v9, 4, v4
    v_and_b32 v10, 15, v2
    v_lshl_add_u32 v9, v10, 8, v9
    v_lshl_add_u32 v245, v1, 12, v9
    v_and_b32 v11, 7, v2
    v_lshlrev_b32 v12, 4, v4
    v_lshl_add_u32 v12, v11, 8, v12
    v_bfe_u32 v11, v2, 3, 1
    v_lshl_add_u32 v12, v11, 6, v12
    v_lshl_add_u32 v242, v1, 12, v12
    v_bfe_u32 v11, v9, 4, 2
    v_lshlrev_b32 v9, 2, v11
    v_xor_b32 v9, v10, v9
    v_lshlrev_b32 v9, 4, v9
    v_lshl_add_u32 v9, v11, 8, v9
    v_add_u32 v251, s13, v9
    v_and_b32 v10, 7, v2
    v_lshrrev_b32 v11, 3, v2
    v_lshlrev_b32 v9, 2, v6
    v_xor_b32 v9, v11, v9
    v_lshlrev_b32 v9, 4, v9
    v_lshl_add_u32 v9, v10, 8, v9
    v_add_u32 v252, s13, v9
    v_xor_b32 v253, 0x80, v252
    v_lshlrev_b32 v9, 4, v10
    v_lshl_add_u32 v9, v11, 8, v9
    v_lshl_add_u32 v254, v1, 12, v9
    v_and_b32 v9, 7, v2
    v_min_u32 v9, 5, v9
    v_lshlrev_b32 v9, 14, v9
    v_lshl_add_u32 v255, v1, 12, v9
    v_mov_b32 v9, 0x3f803f80
    v_mov_b32 v9, 0x3f803f80
    v_cmp_gt_u32 vcc, 2, v6
    s_nop 1
    v_cndmask_b32 v249, 0, v9, vcc
    v_accvgpr_write_b32 a248, v249
    v_accvgpr_write_b32 a249, v249
    v_accvgpr_write_b32 a250, v249
    v_accvgpr_write_b32 a251, v249
    v_accvgpr_write_b32 a224, 0
    v_accvgpr_write_b32 a225, 0
    v_accvgpr_write_b32 a226, 0
    v_accvgpr_write_b32 a227, 0
    v_accvgpr_write_b32 a228, 0
    v_accvgpr_write_b32 a229, 0
    v_accvgpr_write_b32 a230, 0
    v_accvgpr_write_b32 a231, 0
    v_accvgpr_write_b32 a232, 0
    v_accvgpr_write_b32 a233, 0
    v_accvgpr_write_b32 a234, 0
    v_accvgpr_write_b32 a235, 0
    v_accvgpr_write_b32 a236, 0
    v_accvgpr_write_b32 a237, 0
    v_accvgpr_write_b32 a238, 0
    v_accvgpr_write_b32 a239, 0
    v_accvgpr_write_b32 a240, 0
    v_accvgpr_write_b32 a241, 0
    v_accvgpr_write_b32 a242, 0
    v_accvgpr_write_b32 a243, 0
    v_accvgpr_write_b32 a244, 0
    v_accvgpr_write_b32 a245, 0
    v_accvgpr_write_b32 a246, 0
    v_accvgpr_write_b32 a247, 0
    v_xor_b32 v10, v6, v4
    v_cmp_gt_u32 vcc, 2, v10
    s_nop 1
    v_cndmask_b32 v9, 0, v9, vcc
    v_accvgpr_write_b32 a252, v9
    v_accvgpr_write_b32 a253, v9
    v_accvgpr_write_b32 a254, v9
    v_accvgpr_write_b32 a255, v9
    v_and_b32 v10, 1, v6
    v_mul_u32_u24 v10, 0xaaaa, v10
    v_add_u32 v250, 0x4444, v10
    s_mov_b32 s15, 0x3e0293ee
    s_mov_b32 s34, 0x37000000
    s_mov_b32 s32, 0xffff0000
    s_mov_b32 s54, 0x3e0293ee
    s_mov_b32 s55, 0x3e0293ee
    s_mov_b32 vcc_lo, 0xff00ff00
    s_mov_b32 vcc_hi, 0xff00ff00
    s_waitcnt vmcnt(4)
    ds_read_b128 v[96:99], v243 offset:0
    ds_read_b128 v[100:103], v243 offset:256
    ds_read_b128 v[104:107], v243 offset:512
    ds_read_b128 v[108:111], v243 offset:768
    s_add_u32 m0, s13, 8224
    s_mov_b32 s14, 65536
    buffer_load_dwordx4 v244, s[16:19], s14 offen offset:0 nt lds
    buffer_load_dwordx4 v244, s[16:19], s14 offen offset:1024 nt lds
    buffer_load_dwordx4 v244, s[16:19], s14 offen offset:2048 nt lds
    buffer_load_dwordx4 v244, s[16:19], s14 offen offset:3072 nt lds
    s_waitcnt lgkmcnt(3)
    v_lshlrev_b32 v112, 16, v96
    v_and_b32 v113, s32, v96
    v_lshlrev_b32 v114, 16, v97
    v_and_b32 v115, s32, v97
    v_lshlrev_b32 v116, 16, v98
    v_and_b32 v117, s32, v98
    v_lshlrev_b32 v118, 16, v99
    v_and_b32 v119, s32, v99
    v_pk_mul_f32 v[112:113], v[112:113], s[54:55]
    v_pk_mul_f32 v[114:115], v[114:115], s[54:55]
    v_pk_mul_f32 v[116:117], v[116:117], s[54:55]
    v_pk_mul_f32 v[118:119], v[118:119], s[54:55]
    v_cvt_pk_bf16_f32 v96, v112, v113
    v_cvt_pk_bf16_f32 v97, v114, v115
    v_cvt_pk_bf16_f32 v98, v116, v117
    v_cvt_pk_bf16_f32 v99, v118, v119
    v_accvgpr_write_b32 a48, v96
    v_accvgpr_write_b32 a49, v97
    v_accvgpr_write_b32 a50, v98
    v_accvgpr_write_b32 a51, v99
    s_waitcnt lgkmcnt(0)
    v_lshlrev_b32 v120, 16, v100
    v_and_b32 v121, s32, v100
    v_lshlrev_b32 v122, 16, v101
    v_and_b32 v123, s32, v101
    v_lshlrev_b32 v124, 16, v102
    v_and_b32 v125, s32, v102
    v_lshlrev_b32 v126, 16, v103
    v_and_b32 v127, s32, v103
    v_pk_mul_f32 v[120:121], v[120:121], s[54:55]
    v_pk_mul_f32 v[122:123], v[122:123], s[54:55]
    v_pk_mul_f32 v[124:125], v[124:125], s[54:55]
    v_pk_mul_f32 v[126:127], v[126:127], s[54:55]
    v_cvt_pk_bf16_f32 v100, v120, v121
    v_cvt_pk_bf16_f32 v101, v122, v123
    v_cvt_pk_bf16_f32 v102, v124, v125
    v_cvt_pk_bf16_f32 v103, v126, v127
    v_accvgpr_write_b32 a52, v100
    v_accvgpr_write_b32 a53, v101
    v_accvgpr_write_b32 a54, v102
    v_accvgpr_write_b32 a55, v103
    v_lshlrev_b32 v112, 16, v104
    v_and_b32 v113, s32, v104
    v_lshlrev_b32 v114, 16, v105
    v_and_b32 v115, s32, v105
    v_lshlrev_b32 v116, 16, v106
    v_and_b32 v117, s32, v106
    v_lshlrev_b32 v118, 16, v107
    v_and_b32 v119, s32, v107
    v_pk_mul_f32 v[112:113], v[112:113], s[54:55]
    v_pk_mul_f32 v[114:115], v[114:115], s[54:55]
    v_pk_mul_f32 v[116:117], v[116:117], s[54:55]
    v_pk_mul_f32 v[118:119], v[118:119], s[54:55]
    v_cvt_pk_bf16_f32 v104, v112, v113
    v_cvt_pk_bf16_f32 v105, v114, v115
    v_cvt_pk_bf16_f32 v106, v116, v117
    v_cvt_pk_bf16_f32 v107, v118, v119
    v_accvgpr_write_b32 a56, v104
    v_accvgpr_write_b32 a57, v105
    v_accvgpr_write_b32 a58, v106
    v_accvgpr_write_b32 a59, v107
    v_lshlrev_b32 v120, 16, v108
    v_and_b32 v121, s32, v108
    v_lshlrev_b32 v122, 16, v109
    v_and_b32 v123, s32, v109
    v_lshlrev_b32 v124, 16, v110
    v_and_b32 v125, s32, v110
    v_lshlrev_b32 v126, 16, v111
    v_and_b32 v127, s32, v111
    v_pk_mul_f32 v[120:121], v[120:121], s[54:55]
    v_pk_mul_f32 v[122:123], v[122:123], s[54:55]
    v_pk_mul_f32 v[124:125], v[124:125], s[54:55]
    v_pk_mul_f32 v[126:127], v[126:127], s[54:55]
    v_cvt_pk_bf16_f32 v108, v120, v121
    v_cvt_pk_bf16_f32 v109, v122, v123
    v_cvt_pk_bf16_f32 v110, v124, v125
    v_cvt_pk_bf16_f32 v111, v126, v127
    v_accvgpr_write_b32 a60, v108
    v_accvgpr_write_b32 a61, v109
    v_accvgpr_write_b32 a62, v110
    v_accvgpr_write_b32 a63, v111
    s_mov_b64 exec, 0
    s_cmp_eq_u32 s12, 0
    s_cbranch_scc1 L_pad1
    s_cmp_eq_u32 s12, 1
    s_cbranch_scc1 L_pad2
    s_cmp_eq_u32 s12, 2
    s_cbranch_scc1 L_pad3
    s_cmp_eq_u32 s12, 3
    s_cbranch_scc1 L_pad4
L_warm:
    s_mov_b64 exec, -1
    s_waitcnt vmcnt(4)
    s_barrier
    ds_read_b128 a[96:99], v240 offset:4112
    ds_read_b128 a[100:103], v240 offset:4368
    ds_read_b128 a[104:107], v240 offset:4624
    ds_read_b128 a[108:111], v240 offset:4880
    ds_read_b128 a[112:115], v240 offset:5136
    ds_read_b128 a[116:119], v240 offset:5392
    ds_read_b128 a[120:123], v240 offset:5648
    s_add_u32 m0, s13, 12336
    s_mov_b32 s14, 81920
    buffer_load_dwordx4 v244, s[16:19], s14 offen offset:0 nt lds
    buffer_load_dwordx4 v244, s[16:19], s14 offen offset:1024 nt lds
    buffer_load_dwordx4 v244, s[16:19], s14 offen offset:2048 nt lds
    buffer_load_dwordx4 v244, s[16:19], s14 offen offset:3072 nt lds
    s_waitcnt lgkmcnt(6)
    v_mfma_f32_16x16x32_bf16 v[192:195], a[96:99], a[48:51], 0
    s_waitcnt lgkmcnt(5)
    s_mov_b32 s48, 0
    s_mov_b32 s49, 16384
    ds_read_b128 a[124:127], v240 offset:5904
    v_mfma_f32_16x16x32_bf16 v[192:195], a[100:103], a[52:55], v[192:195]
    s_waitcnt lgkmcnt(5)
    s_mov_b32 s50, 32768
    ds_read_b64_tr_b16 a[160:161], v241 offset:4112
    ds_read_b64_tr_b16 a[162:163], v241 offset:5136
    v_mfma_f32_16x16x32_bf16 v[192:195], a[104:107], a[56:59], v[192:195]
    s_waitcnt lgkmcnt(3)
    s_mov_b32 s51, 49152
    ds_read_b64_tr_b16 a[164:165], v241 offset:4120
    ds_read_b64_tr_b16 a[166:167], v241 offset:5144
    v_mfma_f32_16x16x32_bf16 v[192:195], a[108:111], a[60:63], v[192:195]
    s_mov_b32 s52, 65536
    ds_read_b64_tr_b16 a[168:169], v241 offset:4368
    ds_read_b64_tr_b16 a[170:171], v241 offset:5392
    v_mfma_f32_16x16x32_bf16 v[196:199], a[112:115], a[48:51], 0
    s_mov_b32 s53, 81920
    ds_read_b64_tr_b16 a[172:173], v241 offset:4376
    ds_read_b64_tr_b16 a[174:175], v241 offset:5400
    v_mfma_f32_16x16x32_bf16 v[196:199], a[116:119], a[52:55], v[196:199]
    ds_read_b64_tr_b16 a[176:177], v241 offset:4624
    ds_read_b64_tr_b16 a[178:179], v241 offset:5648
    v_mfma_f32_16x16x32_bf16 v[196:199], a[120:123], a[56:59], v[196:199]
    s_waitcnt lgkmcnt(9)
    ds_read_b64_tr_b16 a[180:181], v241 offset:4632
    ds_read_b64_tr_b16 a[182:183], v241 offset:5656
    v_mfma_f32_16x16x32_bf16 v[196:199], a[124:127], a[60:63], v[196:199]
    ds_read_b64_tr_b16 a[184:185], v241 offset:4880
    ds_read_b64_tr_b16 a[186:187], v241 offset:5904
    v_max3_f32 v246, v192, v193, v194
    s_nop 4
    v_max3_f32 v246, v246, v195, v196
    v_max3_f32 v246, v246, v197, v198
    v_max_f32 v246, v246, v199
    v_mov_b32 v247, v246
    s_nop 1
    v_permlane16_swap_b32 v246, v247
    v_max_f32 v246, v246, v247
    v_mov_b32 v247, v246
    s_nop 1
    v_permlane32_swap_b32 v246, v247
    v_max_f32 v246, v246, v247
    v_sub_f32 v228, 0xc2240000, v246
    v_sub_f32 v229, 0xc2240000, v246
    v_sub_f32 v230, 0xc2240000, v246
    v_sub_f32 v231, 0xc2240000, v246
    v_add_f32 v192, v192, v228
    v_exp_f32 v192, v192
    v_add_f32 v193, v193, v228
    v_exp_f32 v193, v193
    v_add_f32 v194, v194, v228
    v_exp_f32 v194, v194
    v_add_f32 v195, v195, v228
    v_exp_f32 v195, v195
    v_add_f32 v196, v196, v228
    v_exp_f32 v196, v196
    v_add_f32 v197, v197, v228
    v_exp_f32 v197, v197
    v_add_f32 v198, v198, v228
    v_exp_f32 v198, v198
    v_add_f32 v199, v199, v228
    v_exp_f32 v199, v199
    v_cvt_pk_bf16_f32 v208, v192, v193
    v_cvt_pk_bf16_f32 v209, v194, v195
    v_cvt_pk_bf16_f32 v210, v196, v197
    v_cvt_pk_bf16_f32 v211, v198, v199
    s_waitcnt lgkmcnt(0)
    s_nop 0
    v_mfma_f32_16x16x32_bf16 v[96:99], a[160:163], v[208:211], 0
    ds_read_b64_tr_b16 a[188:189], v241 offset:4888
    ds_read_b64_tr_b16 a[190:191], v241 offset:5912
    v_mfma_f32_16x16x32_bf16 v[100:103], a[164:167], v[208:211], 0
    v_mfma_f32_16x16x32_bf16 v[104:107], a[168:171], v[208:211], 0
    v_mfma_f32_16x16x32_bf16 v[108:111], a[172:175], v[208:211], 0
    v_mfma_f32_16x16x32_bf16 v[112:115], a[176:179], v[208:211], 0
    v_mfma_f32_16x16x32_bf16 v[116:119], a[180:183], v[208:211], 0
    v_mfma_f32_16x16x32_bf16 v[120:123], a[184:187], v[208:211], 0
    s_waitcnt lgkmcnt(0)
    v_mfma_f32_16x16x32_bf16 v[124:127], a[188:191], v[208:211], 0
    s_waitcnt vmcnt(4)
    ds_read_b128 v[128:131], v243 offset:8224
    ds_read_b128 v[132:135], v243 offset:8480
    ds_read_b128 v[136:139], v243 offset:8736
    ds_read_b128 v[140:143], v243 offset:8992
    s_add_u32 m0, s13, 16448
    s_mov_b32 s14, 8192
    buffer_load_dwordx4 v244, s[20:23], s14 offen offset:0 nt lds
    buffer_load_dwordx4 v244, s[20:23], s14 offen offset:1024 nt lds
    s_add_u32 m0, s92, 16448
    s_nop 0
    buffer_load_dwordx4 v244, s[24:27], s14 offen offset:2048 nt lds
    buffer_load_dwordx4 v244, s[24:27], s14 offen offset:3072 nt lds
    s_waitcnt lgkmcnt(3)
    v_lshlrev_b32 v144, 16, v128
    v_and_b32 v145, s32, v128
    v_lshlrev_b32 v146, 16, v129
    v_and_b32 v147, s32, v129
    v_lshlrev_b32 v148, 16, v130
    v_and_b32 v149, s32, v130
    v_lshlrev_b32 v150, 16, v131
    v_and_b32 v151, s32, v131
    v_pk_mul_f32 v[144:145], v[144:145], s[54:55]
    v_pk_mul_f32 v[146:147], v[146:147], s[54:55]
    v_pk_mul_f32 v[148:149], v[148:149], s[54:55]
    v_pk_mul_f32 v[150:151], v[150:151], s[54:55]
    v_cvt_pk_bf16_f32 v128, v144, v145
    v_cvt_pk_bf16_f32 v129, v146, v147
    v_cvt_pk_bf16_f32 v130, v148, v149
    v_cvt_pk_bf16_f32 v131, v150, v151
    v_accvgpr_write_b32 a64, v128
    v_accvgpr_write_b32 a65, v129
    v_accvgpr_write_b32 a66, v130
    v_accvgpr_write_b32 a67, v131
    s_waitcnt lgkmcnt(0)
    v_lshlrev_b32 v152, 16, v132
    v_and_b32 v153, s32, v132
    v_lshlrev_b32 v154, 16, v133
    v_and_b32 v155, s32, v133
    v_lshlrev_b32 v156, 16, v134
    v_and_b32 v157, s32, v134
    v_lshlrev_b32 v158, 16, v135
    v_and_b32 v159, s32, v135
    v_pk_mul_f32 v[152:153], v[152:153], s[54:55]
    v_pk_mul_f32 v[154:155], v[154:155], s[54:55]
    v_pk_mul_f32 v[156:157], v[156:157], s[54:55]
    v_pk_mul_f32 v[158:159], v[158:159], s[54:55]
    v_cvt_pk_bf16_f32 v132, v152, v153
    v_cvt_pk_bf16_f32 v133, v154, v155
    v_cvt_pk_bf16_f32 v134, v156, v157
    v_cvt_pk_bf16_f32 v135, v158, v159
    v_accvgpr_write_b32 a68, v132
    v_accvgpr_write_b32 a69, v133
    v_accvgpr_write_b32 a70, v134
    v_accvgpr_write_b32 a71, v135
    v_lshlrev_b32 v144, 16, v136
    v_and_b32 v145, s32, v136
    v_lshlrev_b32 v146, 16, v137
    v_and_b32 v147, s32, v137
    v_lshlrev_b32 v148, 16, v138
    v_and_b32 v149, s32, v138
    v_lshlrev_b32 v150, 16, v139
    v_and_b32 v151, s32, v139
    v_pk_mul_f32 v[144:145], v[144:145], s[54:55]
    v_pk_mul_f32 v[146:147], v[146:147], s[54:55]
    v_pk_mul_f32 v[148:149], v[148:149], s[54:55]
    v_pk_mul_f32 v[150:151], v[150:151], s[54:55]
    v_cvt_pk_bf16_f32 v136, v144, v145
    v_cvt_pk_bf16_f32 v137, v146, v147
    v_cvt_pk_bf16_f32 v138, v148, v149
    v_cvt_pk_bf16_f32 v139, v150, v151
    v_accvgpr_write_b32 a72, v136
    v_accvgpr_write_b32 a73, v137
    v_accvgpr_write_b32 a74, v138
    v_accvgpr_write_b32 a75, v139
    v_lshlrev_b32 v152, 16, v140
    v_and_b32 v153, s32, v140
    v_lshlrev_b32 v154, 16, v141
    v_and_b32 v155, s32, v141
    v_lshlrev_b32 v156, 16, v142
    v_and_b32 v157, s32, v142
    v_lshlrev_b32 v158, 16, v143
    v_and_b32 v159, s32, v143
    v_pk_mul_f32 v[152:153], v[152:153], s[54:55]
    v_pk_mul_f32 v[154:155], v[154:155], s[54:55]
    v_pk_mul_f32 v[156:157], v[156:157], s[54:55]
    v_pk_mul_f32 v[158:159], v[158:159], s[54:55]
    v_cvt_pk_bf16_f32 v140, v152, v153
    v_cvt_pk_bf16_f32 v141, v154, v155
    v_cvt_pk_bf16_f32 v142, v156, v157
    v_cvt_pk_bf16_f32 v143, v158, v159
    v_accvgpr_write_b32 a76, v140
    v_accvgpr_write_b32 a77, v141
    v_accvgpr_write_b32 a78, v142
    v_accvgpr_write_b32 a79, v143
    v_mfma_f32_16x16x32_bf16 v[200:203], a[96:99], a[64:67], 0
    v_mfma_f32_16x16x32_bf16 v[200:203], a[100:103], a[68:71], v[200:203]
    v_mfma_f32_16x16x32_bf16 v[200:203], a[104:107], a[72:75], v[200:203]
    v_mfma_f32_16x16x32_bf16 v[200:203], a[108:111], a[76:79], v[200:203]
    v_mfma_f32_16x16x32_bf16 v[204:207], a[112:115], a[64:67], 0
    v_mfma_f32_16x16x32_bf16 v[204:207], a[116:119], a[68:71], v[204:207]
    v_mfma_f32_16x16x32_bf16 v[204:207], a[120:123], a[72:75], v[204:207]
    v_mfma_f32_16x16x32_bf16 v[204:207], a[124:127], a[76:79], v[204:207]
    v_max3_f32 v246, v200, v201, v202
    s_nop 6
    v_max3_f32 v246, v246, v203, v204
    v_max3_f32 v246, v246, v205, v206
    v_max_f32 v246, v246, v207
    v_mov_b32 v247, v246
    s_nop 1
    v_permlane16_swap_b32 v246, v247
    v_max_f32 v246, v246, v247
    v_mov_b32 v247, v246
    s_nop 1
    v_permlane32_swap_b32 v246, v247
    v_max_f32 v246, v246, v247
    v_sub_f32 v232, 0xc2240000, v246
    v_sub_f32 v233, 0xc2240000, v246
    v_sub_f32 v234, 0xc2240000, v246
    v_sub_f32 v235, 0xc2240000, v246
    v_add_f32 v200, v200, v232
    v_exp_f32 v200, v200
    v_add_f32 v201, v201, v232
    v_exp_f32 v201, v201
    v_add_f32 v202, v202, v232
    v_exp_f32 v202, v202
    v_add_f32 v203, v203, v232
    v_exp_f32 v203, v203
    v_add_f32 v204, v204, v232
    v_exp_f32 v204, v204
    v_add_f32 v205, v205, v232
    v_exp_f32 v205, v205
    v_add_f32 v206, v206, v232
    v_exp_f32 v206, v206
    v_add_f32 v207, v207, v232
    v_exp_f32 v207, v207
    v_cvt_pk_bf16_f32 v212, v200, v201
    v_cvt_pk_bf16_f32 v213, v202, v203
    v_cvt_pk_bf16_f32 v214, v204, v205
    v_cvt_pk_bf16_f32 v215, v206, v207
    s_nop 1
    v_smfmac_f32_16x16x64_bf16 a[236:239], a[252:255], v[208:215], v250
    v_mfma_f32_16x16x32_bf16 v[128:131], a[160:163], v[212:215], 0
    v_mfma_f32_16x16x32_bf16 v[132:135], a[164:167], v[212:215], 0
    v_mfma_f32_16x16x32_bf16 v[136:139], a[168:171], v[212:215], 0
    v_mfma_f32_16x16x32_bf16 v[140:143], a[172:175], v[212:215], 0
    v_mfma_f32_16x16x32_bf16 v[144:147], a[176:179], v[212:215], 0
    v_mfma_f32_16x16x32_bf16 v[148:151], a[180:183], v[212:215], 0
    v_mfma_f32_16x16x32_bf16 v[152:155], a[184:187], v[212:215], 0
    v_mfma_f32_16x16x32_bf16 v[156:159], a[188:191], v[212:215], 0
    s_waitcnt vmcnt(4)
    ds_read_b128 v[160:163], v243 offset:12336
    ds_read_b128 v[164:167], v243 offset:12592
    ds_read_b128 v[168:171], v243 offset:12848
    ds_read_b128 v[172:175], v243 offset:13104
    s_add_u32 m0, s13, 0
    s_mov_b32 s14, 32768
    buffer_load_dwordx4 v244, s[16:19], s14 offen offset:0 nt lds
    buffer_load_dwordx4 v244, s[16:19], s14 offen offset:1024 nt lds
    buffer_load_dwordx4 v244, s[16:19], s14 offen offset:2048 nt lds
L_pad1:
    s_cbranch_execz L_pad5
    buffer_load_dwordx4 v244, s[16:19], s14 offen offset:3072 nt lds
    s_waitcnt lgkmcnt(3)
    v_lshlrev_b32 v176, 16, v160
    v_and_b32 v177, s32, v160
    v_lshlrev_b32 v178, 16, v161
    v_and_b32 v179, s32, v161
    v_lshlrev_b32 v180, 16, v162
    v_and_b32 v181, s32, v162
    v_lshlrev_b32 v182, 16, v163
    v_and_b32 v183, s32, v163
    v_pk_mul_f32 v[176:177], v[176:177], s[54:55]
    v_pk_mul_f32 v[178:179], v[178:179], s[54:55]
    v_pk_mul_f32 v[180:181], v[180:181], s[54:55]
    v_pk_mul_f32 v[182:183], v[182:183], s[54:55]
    v_cvt_pk_bf16_f32 v160, v176, v177
    v_cvt_pk_bf16_f32 v161, v178, v179
    v_cvt_pk_bf16_f32 v162, v180, v181
    v_cvt_pk_bf16_f32 v163, v182, v183
    v_accvgpr_write_b32 a80, v160
    v_accvgpr_write_b32 a81, v161
    v_accvgpr_write_b32 a82, v162
    v_accvgpr_write_b32 a83, v163
    s_waitcnt lgkmcnt(0)
    v_lshlrev_b32 v184, 16, v164
    v_and_b32 v185, s32, v164
    v_lshlrev_b32 v186, 16, v165
    v_and_b32 v187, s32, v165
    v_lshlrev_b32 v188, 16, v166
    v_and_b32 v189, s32, v166
    v_lshlrev_b32 v190, 16, v167
    v_and_b32 v191, s32, v167
    v_pk_mul_f32 v[184:185], v[184:185], s[54:55]
    v_pk_mul_f32 v[186:187], v[186:187], s[54:55]
    v_pk_mul_f32 v[188:189], v[188:189], s[54:55]
    v_pk_mul_f32 v[190:191], v[190:191], s[54:55]
    v_cvt_pk_bf16_f32 v164, v184, v185
    v_cvt_pk_bf16_f32 v165, v186, v187
    v_cvt_pk_bf16_f32 v166, v188, v189
    v_cvt_pk_bf16_f32 v167, v190, v191
    v_accvgpr_write_b32 a84, v164
    v_accvgpr_write_b32 a85, v165
    v_accvgpr_write_b32 a86, v166
    v_accvgpr_write_b32 a87, v167
    v_lshlrev_b32 v176, 16, v168
    v_and_b32 v177, s32, v168
    v_lshlrev_b32 v178, 16, v169
    v_and_b32 v179, s32, v169
    v_lshlrev_b32 v180, 16, v170
    v_and_b32 v181, s32, v170
    v_lshlrev_b32 v182, 16, v171
    v_and_b32 v183, s32, v171
    v_pk_mul_f32 v[176:177], v[176:177], s[54:55]
    v_pk_mul_f32 v[178:179], v[178:179], s[54:55]
    v_pk_mul_f32 v[180:181], v[180:181], s[54:55]
    v_pk_mul_f32 v[182:183], v[182:183], s[54:55]
    v_cvt_pk_bf16_f32 v168, v176, v177
    v_cvt_pk_bf16_f32 v169, v178, v179
    v_cvt_pk_bf16_f32 v170, v180, v181
    v_cvt_pk_bf16_f32 v171, v182, v183
    v_accvgpr_write_b32 a88, v168
    v_accvgpr_write_b32 a89, v169
    v_accvgpr_write_b32 a90, v170
    v_accvgpr_write_b32 a91, v171
    v_lshlrev_b32 v184, 16, v172
    v_and_b32 v185, s32, v172
    v_lshlrev_b32 v186, 16, v173
    v_and_b32 v187, s32, v173
    v_lshlrev_b32 v188, 16, v174
    v_and_b32 v189, s32, v174
    v_lshlrev_b32 v190, 16, v175
    v_and_b32 v191, s32, v175
    v_pk_mul_f32 v[184:185], v[184:185], s[54:55]
    v_pk_mul_f32 v[186:187], v[186:187], s[54:55]
    v_pk_mul_f32 v[188:189], v[188:189], s[54:55]
    v_pk_mul_f32 v[190:191], v[190:191], s[54:55]
    v_cvt_pk_bf16_f32 v172, v184, v185
    v_cvt_pk_bf16_f32 v173, v186, v187
    v_cvt_pk_bf16_f32 v174, v188, v189
    v_cvt_pk_bf16_f32 v175, v190, v191
    v_accvgpr_write_b32 a92, v172
    v_accvgpr_write_b32 a93, v173
    v_accvgpr_write_b32 a94, v174
    v_accvgpr_write_b32 a95, v175
    v_mfma_f32_16x16x32_bf16 v[192:195], a[96:99], a[80:83], 0
    v_mfma_f32_16x16x32_bf16 v[192:195], a[100:103], a[84:87], v[192:195]
    v_mfma_f32_16x16x32_bf16 v[192:195], a[104:107], a[88:91], v[192:195]
    v_mfma_f32_16x16x32_bf16 v[192:195], a[108:111], a[92:95], v[192:195]
    v_mfma_f32_16x16x32_bf16 v[196:199], a[112:115], a[80:83], 0
    v_mfma_f32_16x16x32_bf16 v[196:199], a[116:119], a[84:87], v[196:199]
    v_mfma_f32_16x16x32_bf16 v[196:199], a[120:123], a[88:91], v[196:199]
    v_mfma_f32_16x16x32_bf16 v[196:199], a[124:127], a[92:95], v[196:199]
    v_max3_f32 v246, v192, v193, v194
    s_nop 6
    v_max3_f32 v246, v246, v195, v196
    v_max3_f32 v246, v246, v197, v198
    v_max_f32 v246, v246, v199
    v_mov_b32 v247, v246
    s_nop 1
    v_permlane16_swap_b32 v246, v247
    v_max_f32 v246, v246, v247
    v_mov_b32 v247, v246
    s_nop 1
    v_permlane32_swap_b32 v246, v247
    v_max_f32 v246, v246, v247
    v_sub_f32 v236, 0xc2240000, v246
    v_sub_f32 v237, 0xc2240000, v246
    v_sub_f32 v238, 0xc2240000, v246
    v_sub_f32 v239, 0xc2240000, v246
    v_add_f32 v192, v192, v236
    v_exp_f32 v192, v192
    v_add_f32 v193, v193, v236
    v_exp_f32 v193, v193
    v_add_f32 v194, v194, v236
    v_exp_f32 v194, v194
    v_add_f32 v195, v195, v236
    v_exp_f32 v195, v195
    v_add_f32 v196, v196, v236
    v_exp_f32 v196, v196
    v_add_f32 v197, v197, v236
    v_exp_f32 v197, v197
    v_add_f32 v198, v198, v236
    v_exp_f32 v198, v198
    v_add_f32 v199, v199, v236
    v_exp_f32 v199, v199
    v_cvt_pk_bf16_f32 v208, v192, v193
    v_cvt_pk_bf16_f32 v209, v194, v195
    v_cvt_pk_bf16_f32 v210, v196, v197
    v_cvt_pk_bf16_f32 v211, v198, v199
    s_nop 1
    v_mfma_f32_16x16x32_bf16 v[160:163], a[160:163], v[208:211], 0
    v_mfma_f32_16x16x32_bf16 v[164:167], a[164:167], v[208:211], 0
    v_mfma_f32_16x16x32_bf16 v[168:171], a[168:171], v[208:211], 0
    v_mfma_f32_16x16x32_bf16 v[172:175], a[172:175], v[208:211], 0
    v_mfma_f32_16x16x32_bf16 v[176:179], a[176:179], v[208:211], 0
    v_mfma_f32_16x16x32_bf16 v[180:183], a[180:183], v[208:211], 0
    v_mfma_f32_16x16x32_bf16 v[184:187], a[184:187], v[208:211], 0
    v_mfma_f32_16x16x32_bf16 v[188:191], a[188:191], v[208:211], 0
    s_waitcnt vmcnt(6)
    s_barrier
    ds_read_b128 a[128:131], v240 offset:16448
    ds_read_b128 a[132:135], v240 offset:16704
    ds_read_b128 a[136:139], v240 offset:16960
    ds_read_b128 a[140:143], v240 offset:17216
    ds_read_b128 a[144:147], v240 offset:17472
    ds_read_b128 a[148:151], v240 offset:17728
    ds_read_b128 a[152:155], v240 offset:17984
    s_waitcnt lgkmcnt(6)
    v_mfma_f32_16x16x32_bf16 v[200:203], a[128:131], a[80:83], v[236:239]
    s_waitcnt lgkmcnt(5)
    s_add_u32 m0, s13, 8224
    s_mov_b32 s14, 16384
    ds_read_b128 a[156:159], v240 offset:18240
    v_mfma_f32_16x16x32_bf16 v[200:203], a[132:135], a[84:87], v[200:203]
    s_waitcnt lgkmcnt(5)
    buffer_load_dwordx4 v244, s[16:19], s14 offen offset:0 nt lds
    v_mfma_f32_16x16x32_bf16 v[200:203], a[136:139], a[88:91], v[200:203]
    s_waitcnt lgkmcnt(4)
    v_mfma_f32_16x16x32_bf16 v[200:203], a[140:143], a[92:95], v[200:203]
    s_waitcnt lgkmcnt(3)
    s_nop 6
    v_exp_f32 v200, v200
    v_exp_f32 v201, v201
    v_mfma_f32_16x16x32_bf16 v[204:207], a[144:147], a[80:83], v[236:239]
    s_waitcnt lgkmcnt(2)
    v_cvt_pk_bf16_f32 v212, v200, v201
    v_mfma_f32_16x16x32_bf16 v[204:207], a[148:151], a[84:87], v[204:207]
    s_waitcnt lgkmcnt(1)
    buffer_load_dwordx4 v244, s[16:19], s14 offen offset:1024 nt lds
    v_exp_f32 v202, v202
    v_mfma_f32_16x16x32_bf16 v[204:207], a[152:155], a[88:91], v[204:207]
    s_waitcnt lgkmcnt(0)
    v_exp_f32 v203, v203
    v_mfma_f32_16x16x32_bf16 v[204:207], a[156:159], a[92:95], v[204:207]
    s_waitcnt vmcnt(6)
    s_barrier
    v_mfma_f32_16x16x32_bf16 v[192:195], a[128:131], a[48:51], v[228:231]
    s_nop 4
    v_exp_f32 v204, v204
    v_mfma_f32_16x16x32_bf16 v[192:195], a[132:135], a[52:55], v[192:195]
    buffer_load_dwordx4 v244, s[16:19], s14 offen offset:2048 nt lds
    v_exp_f32 v205, v205
    v_mfma_f32_16x16x32_bf16 v[192:195], a[136:139], a[56:59], v[192:195]
    ds_read_b64_tr_b16 a[192:193], v241 offset:16448
    ds_read_b64_tr_b16 a[194:195], v241 offset:17472
    v_cvt_pk_bf16_f32 v213, v202, v203
    v_mfma_f32_16x16x32_bf16 v[192:195], a[140:143], a[60:63], v[192:195]
    ds_read_b64_tr_b16 a[196:197], v241 offset:16456
    ds_read_b64_tr_b16 a[198:199], v241 offset:17480
    v_cvt_pk_bf16_f32 v214, v204, v205
    v_mfma_f32_16x16x32_bf16 v[196:199], a[144:147], a[48:51], v[228:231]
    ds_read_b64_tr_b16 a[200:201], v241 offset:16704
    ds_read_b64_tr_b16 a[202:203], v241 offset:17728
    v_exp_f32 v206, v206
    v_mfma_f32_16x16x32_bf16 v[196:199], a[148:151], a[52:55], v[196:199]
    ds_read_b64_tr_b16 a[204:205], v241 offset:16712
    ds_read_b64_tr_b16 a[206:207], v241 offset:17736
    buffer_load_dwordx4 v244, s[16:19], s14 offen offset:3072 nt lds
    v_exp_f32 v207, v207
    v_mfma_f32_16x16x32_bf16 v[196:199], a[152:155], a[56:59], v[196:199]
    ds_read_b64_tr_b16 a[208:209], v241 offset:16960
    ds_read_b64_tr_b16 a[210:211], v241 offset:17984
    v_cvt_pk_bf16_f32 v215, v206, v207
    v_mfma_f32_16x16x32_bf16 v[196:199], a[156:159], a[60:63], v[196:199]
    ds_read_b64_tr_b16 a[212:213], v241 offset:16968
    ds_read_b64_tr_b16 a[214:215], v241 offset:17992
    v_smfmac_f32_16x16x64_bf16 a[244:247], a[248:251], v[208:215], v250
    s_waitcnt lgkmcnt(9)
    ds_read_b64_tr_b16 a[216:217], v241 offset:17216
    ds_read_b64_tr_b16 a[218:219], v241 offset:18240
    v_mfma_f32_16x16x32_bf16 v[160:163], a[192:195], v[212:215], v[160:163]
    s_waitcnt lgkmcnt(9)
    ds_read_b64_tr_b16 a[220:221], v241 offset:17224
    ds_read_b64_tr_b16 a[222:223], v241 offset:18248
    v_mfma_f32_16x16x32_bf16 v[164:167], a[196:199], v[212:215], v[164:167]
    s_waitcnt lgkmcnt(10)
    v_exp_f32 v192, v192
    v_mfma_f32_16x16x32_bf16 v[168:171], a[200:203], v[212:215], v[168:171]
    s_waitcnt lgkmcnt(8)
    v_exp_f32 v193, v193
    v_mfma_f32_16x16x32_bf16 v[172:175], a[204:207], v[212:215], v[172:175]
    s_waitcnt lgkmcnt(6)
    v_exp_f32 v194, v194
    v_mfma_f32_16x16x32_bf16 v[176:179], a[208:211], v[212:215], v[176:179]
    s_waitcnt lgkmcnt(4)
    v_exp_f32 v195, v195
    v_mfma_f32_16x16x32_bf16 v[180:183], a[212:215], v[212:215], v[180:183]
    s_waitcnt lgkmcnt(2)
    v_cvt_pk_bf16_f32 v208, v192, v193
    v_cvt_pk_bf16_f32 v209, v194, v195
    v_mfma_f32_16x16x32_bf16 v[184:187], a[216:219], v[212:215], v[184:187]
    s_waitcnt lgkmcnt(0)
    v_exp_f32 v196, v196
    v_mfma_f32_16x16x32_bf16 v[188:191], a[220:223], v[212:215], v[188:191]
    v_exp_f32 v197, v197
    v_mfma_f32_16x16x32_bf16 v[200:203], a[128:131], a[64:67], v[232:235]
    v_cvt_pk_bf16_f32 v210, v196, v197
    v_mfma_f32_16x16x32_bf16 v[200:203], a[132:135], a[68:71], v[200:203]
    v_exp_f32 v198, v198
    v_mfma_f32_16x16x32_bf16 v[200:203], a[136:139], a[72:75], v[200:203]
    v_exp_f32 v199, v199
    v_mfma_f32_16x16x32_bf16 v[200:203], a[140:143], a[76:79], v[200:203]
    v_cvt_pk_bf16_f32 v211, v198, v199
    v_mfma_f32_16x16x32_bf16 v[204:207], a[144:147], a[64:67], v[232:235]
    v_mfma_f32_16x16x32_bf16 v[204:207], a[148:151], a[68:71], v[204:207]
    v_mfma_f32_16x16x32_bf16 v[204:207], a[152:155], a[72:75], v[204:207]
    v_exp_f32 v200, v200
    v_mfma_f32_16x16x32_bf16 v[204:207], a[156:159], a[76:79], v[204:207]
    v_exp_f32 v201, v201
    v_mfma_f32_16x16x32_bf16 v[96:99], a[192:195], v[208:211], v[96:99]
    v_exp_f32 v202, v202
    v_mfma_f32_16x16x32_bf16 v[100:103], a[196:199], v[208:211], v[100:103]
    v_exp_f32 v203, v203
    v_mfma_f32_16x16x32_bf16 v[104:107], a[200:203], v[208:211], v[104:107]
    v_cvt_pk_bf16_f32 v212, v200, v201
    v_cvt_pk_bf16_f32 v213, v202, v203
    v_mfma_f32_16x16x32_bf16 v[108:111], a[204:207], v[208:211], v[108:111]
    v_exp_f32 v204, v204
    v_mfma_f32_16x16x32_bf16 v[112:115], a[208:211], v[208:211], v[112:115]
    v_exp_f32 v205, v205
    v_mfma_f32_16x16x32_bf16 v[116:119], a[212:215], v[208:211], v[116:119]
    v_cvt_pk_bf16_f32 v214, v204, v205
    v_mfma_f32_16x16x32_bf16 v[120:123], a[216:219], v[208:211], v[120:123]
    v_exp_f32 v206, v206
    v_mfma_f32_16x16x32_bf16 v[124:127], a[220:223], v[208:211], v[124:127]
    s_waitcnt vmcnt(4)
    ds_read_b128 v[64:67], v243 offset:0
    ds_read_b128 v[68:71], v243 offset:256
    ds_read_b128 v[72:75], v243 offset:512
    ds_read_b128 v[76:79], v243 offset:768
    s_add_u32 m0, s13, 12336
    s_mov_b32 s14, 0
    buffer_load_dwordx4 v244, s[16:19], s14 offen offset:0 nt lds
    buffer_load_dwordx4 v244, s[16:19], s14 offen offset:1024 nt lds
    buffer_load_dwordx4 v244, s[16:19], s14 offen offset:2048 nt lds
    buffer_load_dwordx4 v244, s[16:19], s14 offen offset:3072 nt lds
    s_waitcnt lgkmcnt(3)
    v_lshlrev_b32 v80, 16, v64
    v_and_b32 v81, s32, v64
    v_lshlrev_b32 v82, 16, v65
    v_and_b32 v83, s32, v65
    v_lshlrev_b32 v84, 16, v66
    v_and_b32 v85, s32, v66
    v_lshlrev_b32 v86, 16, v67
    v_and_b32 v87, s32, v67
    v_pk_mul_f32 v[80:81], v[80:81], s[54:55]
    v_pk_mul_f32 v[82:83], v[82:83], s[54:55]
    v_pk_mul_f32 v[84:85], v[84:85], s[54:55]
    v_pk_mul_f32 v[86:87], v[86:87], s[54:55]
    v_cvt_pk_bf16_f32 v64, v80, v81
    v_cvt_pk_bf16_f32 v65, v82, v83
    v_cvt_pk_bf16_f32 v66, v84, v85
    v_cvt_pk_bf16_f32 v67, v86, v87
    v_accvgpr_write_b32 a32, v64
    v_accvgpr_write_b32 a33, v65
    v_accvgpr_write_b32 a34, v66
    v_accvgpr_write_b32 a35, v67
    s_waitcnt lgkmcnt(0)
    v_lshlrev_b32 v88, 16, v68
    v_and_b32 v89, s32, v68
    v_lshlrev_b32 v90, 16, v69
    v_and_b32 v91, s32, v69
    v_lshlrev_b32 v92, 16, v70
    v_and_b32 v93, s32, v70
    v_lshlrev_b32 v94, 16, v71
    v_and_b32 v95, s32, v71
    v_pk_mul_f32 v[88:89], v[88:89], s[54:55]
    v_pk_mul_f32 v[90:91], v[90:91], s[54:55]
    v_pk_mul_f32 v[92:93], v[92:93], s[54:55]
    v_pk_mul_f32 v[94:95], v[94:95], s[54:55]
    v_cvt_pk_bf16_f32 v68, v88, v89
    v_cvt_pk_bf16_f32 v69, v90, v91
    v_cvt_pk_bf16_f32 v70, v92, v93
    v_cvt_pk_bf16_f32 v71, v94, v95
    v_accvgpr_write_b32 a36, v68
    v_accvgpr_write_b32 a37, v69
    v_accvgpr_write_b32 a38, v70
    v_accvgpr_write_b32 a39, v71
    v_lshlrev_b32 v80, 16, v72
    v_and_b32 v81, s32, v72
    v_lshlrev_b32 v82, 16, v73
    v_and_b32 v83, s32, v73
    v_lshlrev_b32 v84, 16, v74
    v_and_b32 v85, s32, v74
    v_lshlrev_b32 v86, 16, v75
    v_and_b32 v87, s32, v75
    v_pk_mul_f32 v[80:81], v[80:81], s[54:55]
    v_pk_mul_f32 v[82:83], v[82:83], s[54:55]
    v_pk_mul_f32 v[84:85], v[84:85], s[54:55]
    v_pk_mul_f32 v[86:87], v[86:87], s[54:55]
    v_cvt_pk_bf16_f32 v72, v80, v81
    v_cvt_pk_bf16_f32 v73, v82, v83
    v_cvt_pk_bf16_f32 v74, v84, v85
    v_cvt_pk_bf16_f32 v75, v86, v87
    v_accvgpr_write_b32 a40, v72
    v_accvgpr_write_b32 a41, v73
    v_accvgpr_write_b32 a42, v74
    v_accvgpr_write_b32 a43, v75
    v_lshlrev_b32 v88, 16, v76
    v_and_b32 v89, s32, v76
    v_lshlrev_b32 v90, 16, v77
    v_and_b32 v91, s32, v77
    v_lshlrev_b32 v92, 16, v78
    v_and_b32 v93, s32, v78
    v_lshlrev_b32 v94, 16, v79
    v_and_b32 v95, s32, v79
    v_pk_mul_f32 v[88:89], v[88:89], s[54:55]
    v_pk_mul_f32 v[90:91], v[90:91], s[54:55]
    v_pk_mul_f32 v[92:93], v[92:93], s[54:55]
    v_pk_mul_f32 v[94:95], v[94:95], s[54:55]
    v_cvt_pk_bf16_f32 v76, v88, v89
    v_cvt_pk_bf16_f32 v77, v90, v91
    v_cvt_pk_bf16_f32 v78, v92, v93
    v_cvt_pk_bf16_f32 v79, v94, v95
    v_accvgpr_write_b32 a44, v76
    v_accvgpr_write_b32 a45, v77
    v_accvgpr_write_b32 a46, v78
    v_accvgpr_write_b32 a47, v79
    v_mfma_f32_16x16x32_bf16 v[192:195], a[96:99], a[32:35], 0
    v_exp_f32 v207, v207
    v_mfma_f32_16x16x32_bf16 v[192:195], a[100:103], a[36:39], v[192:195]
    v_cvt_pk_bf16_f32 v215, v206, v207
    v_mfma_f32_16x16x32_bf16 v[192:195], a[104:107], a[40:43], v[192:195]
    v_mfma_f32_16x16x32_bf16 v[192:195], a[108:111], a[44:47], v[192:195]
    v_mfma_f32_16x16x32_bf16 v[196:199], a[112:115], a[32:35], 0
    v_mfma_f32_16x16x32_bf16 v[196:199], a[116:119], a[36:39], v[196:199]
    v_mfma_f32_16x16x32_bf16 v[196:199], a[120:123], a[40:43], v[196:199]
    v_mfma_f32_16x16x32_bf16 v[196:199], a[124:127], a[44:47], v[196:199]
    v_max3_f32 v246, v192, v193, v194
    s_nop 6
    v_max3_f32 v246, v246, v195, v196
    v_max3_f32 v246, v246, v197, v198
    v_max_f32 v246, v246, v199
    v_mov_b32 v247, v246
    s_nop 1
    v_permlane16_swap_b32 v246, v247
    v_max_f32 v246, v246, v247
    v_smfmac_f32_16x16x64_bf16 a[236:239], a[252:255], v[208:215], v250
    v_mov_b32 v247, v246
    v_mfma_f32_16x16x32_bf16 v[128:131], a[192:195], v[212:215], v[128:131]
    s_nop 0
    v_permlane32_swap_b32 v246, v247
    v_max_f32 v246, v246, v247
    v_sub_f32 v224, 0xc2240000, v246
    v_sub_f32 v225, 0xc2240000, v246
    v_sub_f32 v226, 0xc2240000, v246
    v_sub_f32 v227, 0xc2240000, v246
    v_mfma_f32_16x16x32_bf16 v[132:135], a[196:199], v[212:215], v[132:135]
    v_add_f32 v192, v192, v224
    v_add_f32 v193, v193, v224
    v_mfma_f32_16x16x32_bf16 v[136:139], a[200:203], v[212:215], v[136:139]
    v_exp_f32 v192, v192
    v_mfma_f32_16x16x32_bf16 v[140:143], a[204:207], v[212:215], v[140:143]
    v_exp_f32 v193, v193
    v_mfma_f32_16x16x32_bf16 v[144:147], a[208:211], v[212:215], v[144:147]
    v_add_f32 v194, v194, v224
    v_add_f32 v195, v195, v224
    v_mfma_f32_16x16x32_bf16 v[148:151], a[212:215], v[212:215], v[148:151]
    v_exp_f32 v194, v194
    v_mfma_f32_16x16x32_bf16 v[152:155], a[216:219], v[212:215], v[152:155]
    v_exp_f32 v195, v195
    v_mfma_f32_16x16x32_bf16 v[156:159], a[220:223], v[212:215], v[156:159]
    v_add_f32 v196, v196, v224
    v_cvt_pk_bf16_f32 v208, v192, v193
    v_mfma_f32_16x16x32_bf16 v[200:203], a[128:131], a[32:35], v[224:227]
    v_exp_f32 v196, v196
    v_add_f32 v197, v197, v224
    v_mfma_f32_16x16x32_bf16 v[200:203], a[132:135], a[36:39], v[200:203]
    v_exp_f32 v197, v197
    v_mfma_f32_16x16x32_bf16 v[200:203], a[136:139], a[40:43], v[200:203]
    v_add_f32 v198, v198, v224
    v_cvt_pk_bf16_f32 v209, v194, v195
    v_mfma_f32_16x16x32_bf16 v[200:203], a[140:143], a[44:47], v[200:203]
    v_add_f32 v199, v199, v224
    v_cvt_pk_bf16_f32 v210, v196, v197
    v_mfma_f32_16x16x32_bf16 v[204:207], a[144:147], a[32:35], v[224:227]
    v_exp_f32 v198, v198
    v_mfma_f32_16x16x32_bf16 v[204:207], a[148:151], a[36:39], v[204:207]
    v_exp_f32 v199, v199
    v_mfma_f32_16x16x32_bf16 v[204:207], a[152:155], a[40:43], v[204:207]
    v_cvt_pk_bf16_f32 v211, v198, v199
    v_mfma_f32_16x16x32_bf16 v[204:207], a[156:159], a[44:47], v[204:207]
    v_exp_f32 v200, v200
    v_mfma_f32_16x16x32_bf16 v[64:67], a[160:163], v[208:211], 0
    v_exp_f32 v201, v201
    v_mfma_f32_16x16x32_bf16 v[68:71], a[164:167], v[208:211], 0
    v_exp_f32 v202, v202
    v_mfma_f32_16x16x32_bf16 v[72:75], a[168:171], v[208:211], 0
    v_exp_f32 v203, v203
    v_mfma_f32_16x16x32_bf16 v[76:79], a[172:175], v[208:211], 0
    v_cvt_pk_bf16_f32 v212, v200, v201
    v_cvt_pk_bf16_f32 v213, v202, v203
    v_mfma_f32_16x16x32_bf16 v[80:83], a[176:179], v[208:211], 0
    v_exp_f32 v204, v204
    v_mfma_f32_16x16x32_bf16 v[84:87], a[180:183], v[208:211], 0
    v_exp_f32 v205, v205
    v_mfma_f32_16x16x32_bf16 v[88:91], a[184:187], v[208:211], 0
    v_cvt_pk_bf16_f32 v214, v204, v205
    v_mfma_f32_16x16x32_bf16 v[92:95], a[188:191], v[208:211], 0
    s_waitcnt vmcnt(4)
    ds_read_b128 v[32:35], v243 offset:8224
    ds_read_b128 v[36:39], v243 offset:8480
    ds_read_b128 v[40:43], v243 offset:8736
    ds_read_b128 v[44:47], v243 offset:8992
    s_add_u32 m0, s13, 0
    s_mov_b32 s14, 16384
    buffer_load_dwordx4 v244, s[20:23], s14 offen offset:0 nt lds
    buffer_load_dwordx4 v244, s[20:23], s14 offen offset:1024 nt lds
    s_waitcnt lgkmcnt(3)
    v_lshlrev_b32 v48, 16, v32
    v_and_b32 v49, s32, v32
    v_lshlrev_b32 v50, 16, v33
    v_and_b32 v51, s32, v33
    v_lshlrev_b32 v52, 16, v34
    v_and_b32 v53, s32, v34
    v_lshlrev_b32 v54, 16, v35
    v_and_b32 v55, s32, v35
    v_pk_mul_f32 v[48:49], v[48:49], s[54:55]
    v_pk_mul_f32 v[50:51], v[50:51], s[54:55]
    v_pk_mul_f32 v[52:53], v[52:53], s[54:55]
    v_pk_mul_f32 v[54:55], v[54:55], s[54:55]
    v_cvt_pk_bf16_f32 v32, v48, v49
    v_cvt_pk_bf16_f32 v33, v50, v51
    v_cvt_pk_bf16_f32 v34, v52, v53
    v_cvt_pk_bf16_f32 v35, v54, v55
    v_accvgpr_write_b32 a16, v32
    v_accvgpr_write_b32 a17, v33
    v_accvgpr_write_b32 a18, v34
    v_accvgpr_write_b32 a19, v35
    s_waitcnt lgkmcnt(0)
    v_lshlrev_b32 v56, 16, v36
    v_and_b32 v57, s32, v36
    v_lshlrev_b32 v58, 16, v37
    v_and_b32 v59, s32, v37
    v_lshlrev_b32 v60, 16, v38
    v_and_b32 v61, s32, v38
    v_lshlrev_b32 v62, 16, v39
    v_and_b32 v63, s32, v39
    v_pk_mul_f32 v[56:57], v[56:57], s[54:55]
    v_pk_mul_f32 v[58:59], v[58:59], s[54:55]
    v_pk_mul_f32 v[60:61], v[60:61], s[54:55]
    v_pk_mul_f32 v[62:63], v[62:63], s[54:55]
    v_cvt_pk_bf16_f32 v36, v56, v57
    v_cvt_pk_bf16_f32 v37, v58, v59
    v_cvt_pk_bf16_f32 v38, v60, v61
    v_cvt_pk_bf16_f32 v39, v62, v63
    v_accvgpr_write_b32 a20, v36
    v_accvgpr_write_b32 a21, v37
    v_accvgpr_write_b32 a22, v38
    v_accvgpr_write_b32 a23, v39
    v_lshlrev_b32 v48, 16, v40
    v_and_b32 v49, s32, v40
    v_lshlrev_b32 v50, 16, v41
    v_and_b32 v51, s32, v41
    v_lshlrev_b32 v52, 16, v42
    v_and_b32 v53, s32, v42
    v_lshlrev_b32 v54, 16, v43
    v_and_b32 v55, s32, v43
    v_pk_mul_f32 v[48:49], v[48:49], s[54:55]
    v_pk_mul_f32 v[50:51], v[50:51], s[54:55]
    v_pk_mul_f32 v[52:53], v[52:53], s[54:55]
    v_pk_mul_f32 v[54:55], v[54:55], s[54:55]
    v_cvt_pk_bf16_f32 v40, v48, v49
    v_cvt_pk_bf16_f32 v41, v50, v51
    v_cvt_pk_bf16_f32 v42, v52, v53
    v_cvt_pk_bf16_f32 v43, v54, v55
    v_accvgpr_write_b32 a24, v40
    v_accvgpr_write_b32 a25, v41
    v_accvgpr_write_b32 a26, v42
    v_accvgpr_write_b32 a27, v43
    v_lshlrev_b32 v56, 16, v44
    v_and_b32 v57, s32, v44
    v_lshlrev_b32 v58, 16, v45
    v_and_b32 v59, s32, v45
    v_lshlrev_b32 v60, 16, v46
    v_and_b32 v61, s32, v46
    v_lshlrev_b32 v62, 16, v47
    v_and_b32 v63, s32, v47
    v_pk_mul_f32 v[56:57], v[56:57], s[54:55]
    v_pk_mul_f32 v[58:59], v[58:59], s[54:55]
    v_pk_mul_f32 v[60:61], v[60:61], s[54:55]
    v_pk_mul_f32 v[62:63], v[62:63], s[54:55]
    v_cvt_pk_bf16_f32 v44, v56, v57
    v_cvt_pk_bf16_f32 v45, v58, v59
    v_cvt_pk_bf16_f32 v46, v60, v61
    v_cvt_pk_bf16_f32 v47, v62, v63
    v_accvgpr_write_b32 a28, v44
    v_accvgpr_write_b32 a29, v45
    v_accvgpr_write_b32 a30, v46
    v_accvgpr_write_b32 a31, v47
    v_mfma_f32_16x16x32_bf16 v[192:195], a[96:99], a[16:19], 0
    v_exp_f32 v206, v206
    v_mfma_f32_16x16x32_bf16 v[192:195], a[100:103], a[20:23], v[192:195]
    v_exp_f32 v207, v207
    v_mfma_f32_16x16x32_bf16 v[192:195], a[104:107], a[24:27], v[192:195]
    v_cvt_pk_bf16_f32 v215, v206, v207
    v_mfma_f32_16x16x32_bf16 v[192:195], a[108:111], a[28:31], v[192:195]
    v_mfma_f32_16x16x32_bf16 v[196:199], a[112:115], a[16:19], 0
    v_mfma_f32_16x16x32_bf16 v[196:199], a[116:119], a[20:23], v[196:199]
    v_mfma_f32_16x16x32_bf16 v[196:199], a[120:123], a[24:27], v[196:199]
    v_mfma_f32_16x16x32_bf16 v[196:199], a[124:127], a[28:31], v[196:199]
    v_max3_f32 v246, v192, v193, v194
    s_nop 6
    v_max3_f32 v246, v246, v195, v196
    v_max3_f32 v246, v246, v197, v198
    v_max_f32 v246, v246, v199
    v_mov_b32 v247, v246
    s_nop 1
    v_permlane16_swap_b32 v246, v247
    v_max_f32 v246, v246, v247
    v_smfmac_f32_16x16x64_bf16 a[232:235], a[248:251], v[208:215], v250
    v_mov_b32 v247, v246
    v_mfma_f32_16x16x32_bf16 v[64:67], a[192:195], v[212:215], v[64:67]
    s_nop 0
    v_permlane32_swap_b32 v246, v247
    v_max_f32 v246, v246, v247
    v_sub_f32 v220, 0xc2240000, v246
    v_sub_f32 v221, 0xc2240000, v246
    v_sub_f32 v222, 0xc2240000, v246
    v_sub_f32 v223, 0xc2240000, v246
    v_mfma_f32_16x16x32_bf16 v[68:71], a[196:199], v[212:215], v[68:71]
    v_add_f32 v192, v192, v220
    v_add_f32 v193, v193, v220
    v_mfma_f32_16x16x32_bf16 v[72:75], a[200:203], v[212:215], v[72:75]
    v_exp_f32 v192, v192
    v_mfma_f32_16x16x32_bf16 v[76:79], a[204:207], v[212:215], v[76:79]
    v_exp_f32 v193, v193
    v_mfma_f32_16x16x32_bf16 v[80:83], a[208:211], v[212:215], v[80:83]
    v_add_f32 v194, v194, v220
    v_add_f32 v195, v195, v220
    v_mfma_f32_16x16x32_bf16 v[84:87], a[212:215], v[212:215], v[84:87]
    v_exp_f32 v194, v194
    v_mfma_f32_16x16x32_bf16 v[88:91], a[216:219], v[212:215], v[88:91]
    v_exp_f32 v195, v195
    v_mfma_f32_16x16x32_bf16 v[92:95], a[220:223], v[212:215], v[92:95]
    v_add_f32 v196, v196, v220
    v_cvt_pk_bf16_f32 v208, v192, v193
    v_mfma_f32_16x16x32_bf16 v[200:203], a[128:131], a[16:19], v[220:223]
    v_exp_f32 v196, v196
    v_add_f32 v197, v197, v220
    v_mfma_f32_16x16x32_bf16 v[200:203], a[132:135], a[20:23], v[200:203]
    v_exp_f32 v197, v197
    v_mfma_f32_16x16x32_bf16 v[200:203], a[136:139], a[24:27], v[200:203]
    v_add_f32 v198, v198, v220
    v_cvt_pk_bf16_f32 v209, v194, v195
    v_mfma_f32_16x16x32_bf16 v[200:203], a[140:143], a[28:31], v[200:203]
    v_add_f32 v199, v199, v220
    v_cvt_pk_bf16_f32 v210, v196, v197
    v_mfma_f32_16x16x32_bf16 v[204:207], a[144:147], a[16:19], v[220:223]
    v_exp_f32 v198, v198
    v_mfma_f32_16x16x32_bf16 v[204:207], a[148:151], a[20:23], v[204:207]
    v_exp_f32 v199, v199
    v_mfma_f32_16x16x32_bf16 v[204:207], a[152:155], a[24:27], v[204:207]
    v_cvt_pk_bf16_f32 v211, v198, v199
    v_mfma_f32_16x16x32_bf16 v[204:207], a[156:159], a[28:31], v[204:207]
    v_exp_f32 v200, v200
    v_mfma_f32_16x16x32_bf16 v[32:35], a[160:163], v[208:211], 0
    v_exp_f32 v201, v201
    v_mfma_f32_16x16x32_bf16 v[36:39], a[164:167], v[208:211], 0
    v_exp_f32 v202, v202
    v_mfma_f32_16x16x32_bf16 v[40:43], a[168:171], v[208:211], 0
    v_exp_f32 v203, v203
    v_mfma_f32_16x16x32_bf16 v[44:47], a[172:175], v[208:211], 0
    v_cvt_pk_bf16_f32 v212, v200, v201
    v_cvt_pk_bf16_f32 v213, v202, v203
    v_mfma_f32_16x16x32_bf16 v[48:51], a[176:179], v[208:211], 0
    v_exp_f32 v204, v204
    v_mfma_f32_16x16x32_bf16 v[52:55], a[180:183], v[208:211], 0
    v_exp_f32 v205, v205
    v_mfma_f32_16x16x32_bf16 v[56:59], a[184:187], v[208:211], 0
    v_cvt_pk_bf16_f32 v214, v204, v205
    v_mfma_f32_16x16x32_bf16 v[60:63], a[188:191], v[208:211], 0
    s_waitcnt vmcnt(2)
    ds_read_b128 a[0:3], v243 offset:12336
    ds_read_b128 a[4:7], v243 offset:12592
    ds_read_b128 a[8:11], v243 offset:12848
    ds_read_b128 a[12:15], v243 offset:13104
    s_waitcnt lgkmcnt(3)
    v_mfma_f32_16x16x32_bf16 v[192:195], a[96:99], a[0:3], 0
    s_waitcnt lgkmcnt(2)
    s_add_u32 m0, s92, 0
    s_nop 0
    buffer_load_dwordx4 v244, s[24:27], s14 offen offset:2048 nt lds
    v_mfma_f32_16x16x32_bf16 v[192:195], a[100:103], a[4:7], v[192:195]
    s_waitcnt lgkmcnt(1)
    v_exp_f32 v206, v206
    v_mfma_f32_16x16x32_bf16 v[192:195], a[104:107], a[8:11], v[192:195]
    s_waitcnt lgkmcnt(0)
    v_exp_f32 v207, v207
    v_mfma_f32_16x16x32_bf16 v[192:195], a[108:111], a[12:15], v[192:195]
    v_cvt_pk_bf16_f32 v215, v206, v207
    v_mfma_f32_16x16x32_bf16 v[196:199], a[112:115], a[0:3], 0
    buffer_load_dwordx4 v244, s[24:27], s14 offen offset:3072 nt lds
    v_mfma_f32_16x16x32_bf16 v[196:199], a[116:119], a[4:7], v[196:199]
    v_mfma_f32_16x16x32_bf16 v[196:199], a[120:123], a[8:11], v[196:199]
L_pad2:
    s_cbranch_execz L_pad6
    v_mfma_f32_16x16x32_bf16 v[196:199], a[124:127], a[12:15], v[196:199]
    v_max3_f32 v246, v192, v193, v194
    s_nop 6
    v_max3_f32 v246, v246, v195, v196
    v_max3_f32 v246, v246, v197, v198
    v_max_f32 v246, v246, v199
    v_mov_b32 v247, v246
    s_nop 1
    v_permlane16_swap_b32 v246, v247
    v_max_f32 v246, v246, v247
    v_smfmac_f32_16x16x64_bf16 a[228:231], a[248:251], v[208:215], v250
    v_mov_b32 v247, v246
    v_mfma_f32_16x16x32_bf16 v[32:35], a[192:195], v[212:215], v[32:35]
    s_nop 0
    v_permlane32_swap_b32 v246, v247
    v_max_f32 v246, v246, v247
    v_mul_f32 v216, 0xbe0293ee, v246
    v_add_f32 v216, 0xc2240000, v216
    v_mfma_f32_16x16x32_bf16 v[36:39], a[196:199], v[212:215], v[36:39]
    v_fma_f32 v192, v192, s15, v216
    v_fma_f32 v193, v193, s15, v216
    v_mfma_f32_16x16x32_bf16 v[40:43], a[200:203], v[212:215], v[40:43]
    v_exp_f32 v192, v192
    v_mfma_f32_16x16x32_bf16 v[44:47], a[204:207], v[212:215], v[44:47]
    v_exp_f32 v193, v193
    v_mfma_f32_16x16x32_bf16 v[48:51], a[208:211], v[212:215], v[48:51]
    v_fma_f32 v194, v194, s15, v216
    v_fma_f32 v195, v195, s15, v216
    v_mfma_f32_16x16x32_bf16 v[52:55], a[212:215], v[212:215], v[52:55]
    v_exp_f32 v194, v194
    v_mfma_f32_16x16x32_bf16 v[56:59], a[216:219], v[212:215], v[56:59]
    v_exp_f32 v195, v195
    v_mfma_f32_16x16x32_bf16 v[60:63], a[220:223], v[212:215], v[60:63]
    v_fma_f32 v196, v196, s15, v216
    v_cvt_pk_bf16_f32 v208, v192, v193
    v_mfma_f32_16x16x32_bf16 v[200:203], a[128:131], a[0:3], 0
    v_exp_f32 v196, v196
    v_fma_f32 v197, v197, s15, v216
    v_mfma_f32_16x16x32_bf16 v[200:203], a[132:135], a[4:7], v[200:203]
    v_exp_f32 v197, v197
    v_mfma_f32_16x16x32_bf16 v[200:203], a[136:139], a[8:11], v[200:203]
    v_fma_f32 v198, v198, s15, v216
    v_cvt_pk_bf16_f32 v209, v194, v195
    v_mfma_f32_16x16x32_bf16 v[200:203], a[140:143], a[12:15], v[200:203]
    v_fma_f32 v199, v199, s15, v216
    v_cvt_pk_bf16_f32 v210, v196, v197
    v_mfma_f32_16x16x32_bf16 v[204:207], a[144:147], a[0:3], 0
    v_exp_f32 v198, v198
    v_mfma_f32_16x16x32_bf16 v[204:207], a[148:151], a[4:7], v[204:207]
    v_exp_f32 v199, v199
    v_mfma_f32_16x16x32_bf16 v[204:207], a[152:155], a[8:11], v[204:207]
    v_cvt_pk_bf16_f32 v211, v198, v199
    v_fma_f32 v200, v200, s15, v216
    v_mfma_f32_16x16x32_bf16 v[204:207], a[156:159], a[12:15], v[204:207]
    v_fma_f32 v201, v201, s15, v216
    v_fma_f32 v202, v202, s15, v216
    v_mfma_f32_16x16x32_bf16 v[0:3], a[160:163], v[208:211], 0
    v_exp_f32 v200, v200
    v_mfma_f32_16x16x32_bf16 v[4:7], a[164:167], v[208:211], 0
    v_exp_f32 v201, v201
    v_mfma_f32_16x16x32_bf16 v[8:11], a[168:171], v[208:211], 0
    v_fma_f32 v203, v203, s15, v216
    v_fma_f32 v204, v204, s15, v216
    v_mfma_f32_16x16x32_bf16 v[12:15], a[172:175], v[208:211], 0
    v_exp_f32 v202, v202
    v_mfma_f32_16x16x32_bf16 v[16:19], a[176:179], v[208:211], 0
    v_exp_f32 v203, v203
    v_mfma_f32_16x16x32_bf16 v[20:23], a[180:183], v[208:211], 0
    v_cvt_pk_bf16_f32 v212, v200, v201
    v_fma_f32 v205, v205, s15, v216
    v_mfma_f32_16x16x32_bf16 v[24:27], a[184:187], v[208:211], 0
    v_exp_f32 v204, v204
    v_mfma_f32_16x16x32_bf16 v[28:31], a[188:191], v[208:211], 0
    s_waitcnt vmcnt(2)
    s_barrier
    ds_read_b128 a[96:99], v240 offset:0
    ds_read_b128 a[100:103], v240 offset:256
    ds_read_b128 a[104:107], v240 offset:512
    ds_read_b128 a[108:111], v240 offset:768
    ds_read_b128 a[112:115], v240 offset:1024
    ds_read_b128 a[116:119], v240 offset:1280
    ds_read_b128 a[120:123], v240 offset:1536
    s_waitcnt lgkmcnt(6)
    v_mfma_f32_16x16x32_bf16 v[192:195], a[96:99], a[0:3], 0
    s_waitcnt lgkmcnt(5)
    s_add_u32 m0, s13, 4112
    s_mov_b32 s14, 24576
    ds_read_b128 a[124:127], v240 offset:1792
    v_mfma_f32_16x16x32_bf16 v[192:195], a[100:103], a[4:7], v[192:195]
    s_waitcnt lgkmcnt(5)
    buffer_load_dwordx4 v244, s[20:23], s14 offen offset:0 nt lds
    v_exp_f32 v205, v205
    v_mfma_f32_16x16x32_bf16 v[192:195], a[104:107], a[8:11], v[192:195]
    s_waitcnt lgkmcnt(4)
    v_fma_f32 v206, v206, s15, v216
    v_cvt_pk_bf16_f32 v213, v202, v203
    v_mfma_f32_16x16x32_bf16 v[192:195], a[108:111], a[12:15], v[192:195]
    s_waitcnt lgkmcnt(3)
    v_fma_f32 v207, v207, s15, v216
    v_cvt_pk_bf16_f32 v214, v204, v205
    v_mfma_f32_16x16x32_bf16 v[196:199], a[112:115], a[0:3], 0
    s_waitcnt lgkmcnt(2)
    v_exp_f32 v206, v206
    v_mfma_f32_16x16x32_bf16 v[196:199], a[116:119], a[4:7], v[196:199]
    s_waitcnt lgkmcnt(1)
    buffer_load_dwordx4 v244, s[20:23], s14 offen offset:1024 nt lds
    v_exp_f32 v207, v207
    v_mfma_f32_16x16x32_bf16 v[196:199], a[120:123], a[8:11], v[196:199]
    s_waitcnt lgkmcnt(0)
    v_cvt_pk_bf16_f32 v215, v206, v207
    v_fma_f32 v192, v192, s15, v216
    v_mfma_f32_16x16x32_bf16 v[196:199], a[124:127], a[12:15], v[196:199]
    v_fma_f32 v193, v193, s15, v216
    v_fma_f32 v194, v194, s15, v216
    v_smfmac_f32_16x16x64_bf16 a[224:227], a[248:251], v[208:215], v250
    v_exp_f32 v192, v192
    v_mfma_f32_16x16x32_bf16 v[0:3], a[192:195], v[212:215], v[0:3]
    v_exp_f32 v193, v193
    v_mfma_f32_16x16x32_bf16 v[4:7], a[196:199], v[212:215], v[4:7]
    v_fma_f32 v195, v195, s15, v216
    v_fma_f32 v196, v196, s15, v216
    v_mfma_f32_16x16x32_bf16 v[8:11], a[200:203], v[212:215], v[8:11]
    v_exp_f32 v194, v194
    v_mfma_f32_16x16x32_bf16 v[12:15], a[204:207], v[212:215], v[12:15]
    v_exp_f32 v195, v195
    v_mfma_f32_16x16x32_bf16 v[16:19], a[208:211], v[212:215], v[16:19]
    v_cvt_pk_bf16_f32 v208, v192, v193
    v_fma_f32 v197, v197, s15, v216
    v_mfma_f32_16x16x32_bf16 v[20:23], a[212:215], v[212:215], v[20:23]
    v_exp_f32 v196, v196
    v_mfma_f32_16x16x32_bf16 v[24:27], a[216:219], v[212:215], v[24:27]
    v_exp_f32 v197, v197
    v_mfma_f32_16x16x32_bf16 v[28:31], a[220:223], v[212:215], v[28:31]
    s_waitcnt vmcnt(2)
    s_barrier
    v_mfma_f32_16x16x32_bf16 v[200:203], a[96:99], a[16:19], v[220:223]
    ds_read_b64_tr_b16 a[160:161], v241 offset:0
    ds_read_b64_tr_b16 a[162:163], v241 offset:1024
    v_mfma_f32_16x16x32_bf16 v[200:203], a[100:103], a[20:23], v[200:203]
    v_fma_f32 v198, v198, s15, v216
    v_cvt_pk_bf16_f32 v209, v194, v195
    v_mfma_f32_16x16x32_bf16 v[200:203], a[104:107], a[24:27], v[200:203]
    ds_read_b64_tr_b16 a[164:165], v241 offset:8
    ds_read_b64_tr_b16 a[166:167], v241 offset:1032
    v_mfma_f32_16x16x32_bf16 v[200:203], a[108:111], a[28:31], v[200:203]
    ds_read_b64_tr_b16 a[168:169], v241 offset:256
    ds_read_b64_tr_b16 a[170:171], v241 offset:1280
    v_fma_f32 v199, v199, s15, v216
    v_cvt_pk_bf16_f32 v210, v196, v197
    v_mfma_f32_16x16x32_bf16 v[204:207], a[112:115], a[16:19], v[220:223]
    ds_read_b64_tr_b16 a[172:173], v241 offset:264
    ds_read_b64_tr_b16 a[174:175], v241 offset:1288
    v_exp_f32 v198, v198
    v_mfma_f32_16x16x32_bf16 v[204:207], a[116:119], a[20:23], v[204:207]
    ds_read_b64_tr_b16 a[176:177], v241 offset:512
    ds_read_b64_tr_b16 a[178:179], v241 offset:1536
    v_exp_f32 v199, v199
    v_mfma_f32_16x16x32_bf16 v[204:207], a[120:123], a[24:27], v[204:207]
    ds_read_b64_tr_b16 a[180:181], v241 offset:520
    ds_read_b64_tr_b16 a[182:183], v241 offset:1544
    v_cvt_pk_bf16_f32 v211, v198, v199
    v_mfma_f32_16x16x32_bf16 v[204:207], a[124:127], a[28:31], v[204:207]
    s_waitcnt lgkmcnt(9)
    ds_read_b64_tr_b16 a[184:185], v241 offset:768
    ds_read_b64_tr_b16 a[186:187], v241 offset:1792
    v_mfma_f32_16x16x32_bf16 v[0:3], a[160:163], v[208:211], v[0:3]
    s_waitcnt lgkmcnt(8)
    ds_read_b64_tr_b16 a[188:189], v241 offset:776
    ds_read_b64_tr_b16 a[190:191], v241 offset:1800
    v_mfma_f32_16x16x32_bf16 v[4:7], a[164:167], v[208:211], v[4:7]
    v_exp_f32 v200, v200
    v_mfma_f32_16x16x32_bf16 v[8:11], a[168:171], v[208:211], v[8:11]
    s_waitcnt lgkmcnt(8)
    v_exp_f32 v201, v201
    v_mfma_f32_16x16x32_bf16 v[12:15], a[172:175], v[208:211], v[12:15]
    s_waitcnt lgkmcnt(6)
    v_exp_f32 v202, v202
    v_mfma_f32_16x16x32_bf16 v[16:19], a[176:179], v[208:211], v[16:19]
    s_waitcnt lgkmcnt(4)
    v_exp_f32 v203, v203
    v_mfma_f32_16x16x32_bf16 v[20:23], a[180:183], v[208:211], v[20:23]
    s_waitcnt lgkmcnt(2)
    v_cvt_pk_bf16_f32 v212, v200, v201
    v_cvt_pk_bf16_f32 v213, v202, v203
    v_mfma_f32_16x16x32_bf16 v[24:27], a[184:187], v[208:211], v[24:27]
    s_waitcnt lgkmcnt(0)
    v_exp_f32 v204, v204
    v_mfma_f32_16x16x32_bf16 v[28:31], a[188:191], v[208:211], v[28:31]
    s_add_u32 m0, s92, 4112
    v_exp_f32 v205, v205
    v_mfma_f32_16x16x32_bf16 v[192:195], a[96:99], a[48:51], v[228:231]
    buffer_load_dwordx4 v244, s[24:27], s14 offen offset:2048 nt lds
    v_mfma_f32_16x16x32_bf16 v[192:195], a[100:103], a[52:55], v[192:195]
    v_cvt_pk_bf16_f32 v214, v204, v205
    v_mfma_f32_16x16x32_bf16 v[192:195], a[104:107], a[56:59], v[192:195]
    v_exp_f32 v206, v206
    v_mfma_f32_16x16x32_bf16 v[192:195], a[108:111], a[60:63], v[192:195]
    v_exp_f32 v207, v207
    v_mfma_f32_16x16x32_bf16 v[196:199], a[112:115], a[48:51], v[228:231]
    buffer_load_dwordx4 v244, s[24:27], s14 offen offset:3072 nt lds
    v_mfma_f32_16x16x32_bf16 v[196:199], a[116:119], a[52:55], v[196:199]
    v_cvt_pk_bf16_f32 v215, v206, v207
    v_mfma_f32_16x16x32_bf16 v[196:199], a[120:123], a[56:59], v[196:199]
    v_exp_f32 v192, v192
    v_mfma_f32_16x16x32_bf16 v[196:199], a[124:127], a[60:63], v[196:199]
    v_exp_f32 v193, v193
    v_smfmac_f32_16x16x64_bf16 a[224:227], a[252:255], v[208:215], v250
    v_exp_f32 v194, v194
    v_mfma_f32_16x16x32_bf16 v[32:35], a[160:163], v[212:215], v[32:35]
    v_exp_f32 v195, v195
    v_mfma_f32_16x16x32_bf16 v[36:39], a[164:167], v[212:215], v[36:39]
    v_cvt_pk_bf16_f32 v208, v192, v193
    v_cvt_pk_bf16_f32 v209, v194, v195
    v_mfma_f32_16x16x32_bf16 v[40:43], a[168:171], v[212:215], v[40:43]
    v_exp_f32 v196, v196
    v_mfma_f32_16x16x32_bf16 v[44:47], a[172:175], v[212:215], v[44:47]
    v_exp_f32 v197, v197
    v_mfma_f32_16x16x32_bf16 v[48:51], a[176:179], v[212:215], v[48:51]
    v_cvt_pk_bf16_f32 v210, v196, v197
    v_mfma_f32_16x16x32_bf16 v[52:55], a[180:183], v[212:215], v[52:55]
    v_exp_f32 v198, v198
    v_mfma_f32_16x16x32_bf16 v[56:59], a[184:187], v[212:215], v[56:59]
    v_exp_f32 v199, v199
    v_mfma_f32_16x16x32_bf16 v[60:63], a[188:191], v[212:215], v[60:63]
    v_cvt_pk_bf16_f32 v211, v198, v199
    v_mfma_f32_16x16x32_bf16 v[200:203], a[96:99], a[64:67], v[232:235]
    v_mfma_f32_16x16x32_bf16 v[200:203], a[100:103], a[68:71], v[200:203]
    v_mfma_f32_16x16x32_bf16 v[200:203], a[104:107], a[72:75], v[200:203]
    v_mfma_f32_16x16x32_bf16 v[200:203], a[108:111], a[76:79], v[200:203]
    v_mfma_f32_16x16x32_bf16 v[204:207], a[112:115], a[64:67], v[232:235]
    v_mfma_f32_16x16x32_bf16 v[204:207], a[116:119], a[68:71], v[204:207]
    v_mfma_f32_16x16x32_bf16 v[204:207], a[120:123], a[72:75], v[204:207]
    v_exp_f32 v200, v200
    v_mfma_f32_16x16x32_bf16 v[204:207], a[124:127], a[76:79], v[204:207]
    v_exp_f32 v201, v201
    v_mfma_f32_16x16x32_bf16 v[96:99], a[160:163], v[208:211], v[96:99]
    v_exp_f32 v202, v202
    v_mfma_f32_16x16x32_bf16 v[100:103], a[164:167], v[208:211], v[100:103]
    v_exp_f32 v203, v203
    v_mfma_f32_16x16x32_bf16 v[104:107], a[168:171], v[208:211], v[104:107]
    v_cvt_pk_bf16_f32 v212, v200, v201
    v_cvt_pk_bf16_f32 v213, v202, v203
    v_mfma_f32_16x16x32_bf16 v[108:111], a[172:175], v[208:211], v[108:111]
    v_exp_f32 v204, v204
    v_mfma_f32_16x16x32_bf16 v[112:115], a[176:179], v[208:211], v[112:115]
    v_exp_f32 v205, v205
    v_mfma_f32_16x16x32_bf16 v[116:119], a[180:183], v[208:211], v[116:119]
    v_cvt_pk_bf16_f32 v214, v204, v205
    v_mfma_f32_16x16x32_bf16 v[120:123], a[184:187], v[208:211], v[120:123]
    v_exp_f32 v206, v206
    v_mfma_f32_16x16x32_bf16 v[124:127], a[188:191], v[208:211], v[124:127]
    s_add_u32 m0, s13, 8224
    s_mov_b32 s14, 32768
    v_mfma_f32_16x16x32_bf16 v[192:195], a[96:99], a[32:35], v[224:227]
    buffer_load_dwordx4 v244, s[20:23], s14 offen offset:0 nt lds
    v_mfma_f32_16x16x32_bf16 v[192:195], a[100:103], a[36:39], v[192:195]
    v_exp_f32 v207, v207
    v_mfma_f32_16x16x32_bf16 v[192:195], a[104:107], a[40:43], v[192:195]
    v_cvt_pk_bf16_f32 v215, v206, v207
    v_mfma_f32_16x16x32_bf16 v[192:195], a[108:111], a[44:47], v[192:195]
    v_mfma_f32_16x16x32_bf16 v[196:199], a[112:115], a[32:35], v[224:227]
    buffer_load_dwordx4 v244, s[20:23], s14 offen offset:1024 nt lds
    v_mfma_f32_16x16x32_bf16 v[196:199], a[116:119], a[36:39], v[196:199]
    s_add_u32 m0, s92, 8224
    v_mfma_f32_16x16x32_bf16 v[196:199], a[120:123], a[40:43], v[196:199]
    v_exp_f32 v192, v192
    v_mfma_f32_16x16x32_bf16 v[196:199], a[124:127], a[44:47], v[196:199]
    v_exp_f32 v193, v193
    v_smfmac_f32_16x16x64_bf16 a[236:239], a[252:255], v[208:215], v250
    buffer_load_dwordx4 v244, s[24:27], s14 offen offset:2048 nt lds
    v_mfma_f32_16x16x32_bf16 v[128:131], a[160:163], v[212:215], v[128:131]
    v_exp_f32 v194, v194
    v_mfma_f32_16x16x32_bf16 v[132:135], a[164:167], v[212:215], v[132:135]
    v_exp_f32 v195, v195
    v_mfma_f32_16x16x32_bf16 v[136:139], a[168:171], v[212:215], v[136:139]
    v_cvt_pk_bf16_f32 v208, v192, v193
    v_cvt_pk_bf16_f32 v209, v194, v195
    v_mfma_f32_16x16x32_bf16 v[140:143], a[172:175], v[212:215], v[140:143]
    buffer_load_dwordx4 v244, s[24:27], s14 offen offset:3072 nt lds
    v_mfma_f32_16x16x32_bf16 v[144:147], a[176:179], v[212:215], v[144:147]
    v_exp_f32 v196, v196
    v_mfma_f32_16x16x32_bf16 v[148:151], a[180:183], v[212:215], v[148:151]
    v_exp_f32 v197, v197
    v_mfma_f32_16x16x32_bf16 v[152:155], a[184:187], v[212:215], v[152:155]
    v_cvt_pk_bf16_f32 v210, v196, v197
    v_mfma_f32_16x16x32_bf16 v[156:159], a[188:191], v[212:215], v[156:159]
    s_waitcnt vmcnt(6)
    s_barrier
    v_mfma_f32_16x16x32_bf16 v[200:203], a[96:99], a[80:83], v[236:239]
    v_exp_f32 v198, v198
    v_mfma_f32_16x16x32_bf16 v[200:203], a[100:103], a[84:87], v[200:203]
    v_exp_f32 v199, v199
    v_mfma_f32_16x16x32_bf16 v[200:203], a[104:107], a[88:91], v[200:203]
    ds_read_b128 a[128:131], v240 offset:4112
    v_cvt_pk_bf16_f32 v211, v198, v199
    v_mfma_f32_16x16x32_bf16 v[200:203], a[108:111], a[92:95], v[200:203]
    v_mfma_f32_16x16x32_bf16 v[204:207], a[112:115], a[80:83], v[236:239]
    ds_read_b128 a[132:135], v240 offset:4368
    v_mfma_f32_16x16x32_bf16 v[204:207], a[116:119], a[84:87], v[204:207]
    v_mfma_f32_16x16x32_bf16 v[204:207], a[120:123], a[88:91], v[204:207]
    v_exp_f32 v200, v200
    v_mfma_f32_16x16x32_bf16 v[204:207], a[124:127], a[92:95], v[204:207]
    v_exp_f32 v201, v201
    v_mfma_f32_16x16x32_bf16 v[64:67], a[160:163], v[208:211], v[64:67]
    ds_read_b128 a[136:139], v240 offset:4624
    v_cvt_pk_bf16_f32 v212, v200, v201
    v_mfma_f32_16x16x32_bf16 v[68:71], a[164:167], v[208:211], v[68:71]
    v_exp_f32 v202, v202
    v_mfma_f32_16x16x32_bf16 v[72:75], a[168:171], v[208:211], v[72:75]
    ds_read_b128 a[140:143], v240 offset:4880
    v_mfma_f32_16x16x32_bf16 v[76:79], a[172:175], v[208:211], v[76:79]
    v_exp_f32 v203, v203
    v_mfma_f32_16x16x32_bf16 v[80:83], a[176:179], v[208:211], v[80:83]
    ds_read_b128 a[144:147], v240 offset:5136
    v_cvt_pk_bf16_f32 v213, v202, v203
    v_mfma_f32_16x16x32_bf16 v[84:87], a[180:183], v[208:211], v[84:87]
    v_exp_f32 v204, v204
    v_mfma_f32_16x16x32_bf16 v[88:91], a[184:187], v[208:211], v[88:91]
    ds_read_b128 a[148:151], v240 offset:5392
    v_mfma_f32_16x16x32_bf16 v[92:95], a[188:191], v[208:211], v[92:95]
    s_waitcnt vmcnt(4) lgkmcnt(4)
    ds_read_b128 a[152:155], v240 offset:5648
    v_mfma_f32_16x16x32_bf16 v[192:195], a[128:131], a[0:3], 0
    ds_read_b128 a[156:159], v240 offset:5904
    s_barrier
    v_mfma_f32_16x16x32_bf16 v[192:195], a[132:135], a[4:7], v[192:195]
    s_waitcnt lgkmcnt(5)
    v_exp_f32 v205, v205
    v_mfma_f32_16x16x32_bf16 v[192:195], a[136:139], a[8:11], v[192:195]
    s_waitcnt lgkmcnt(4)
    ds_read_b64_tr_b16 a[192:193], v241 offset:4112
    v_cvt_pk_bf16_f32 v214, v204, v205
    v_mfma_f32_16x16x32_bf16 v[192:195], a[140:143], a[12:15], v[192:195]
    s_waitcnt lgkmcnt(4)
    v_exp_f32 v206, v206
    v_mfma_f32_16x16x32_bf16 v[196:199], a[144:147], a[0:3], 0
    s_waitcnt lgkmcnt(3)
    v_exp_f32 v207, v207
    v_mfma_f32_16x16x32_bf16 v[196:199], a[148:151], a[4:7], v[196:199]
    s_waitcnt lgkmcnt(2)
    ds_read_b64_tr_b16 a[194:195], v241 offset:5136
    v_cvt_pk_bf16_f32 v215, v206, v207
    v_mfma_f32_16x16x32_bf16 v[196:199], a[152:155], a[8:11], v[196:199]
    s_waitcnt lgkmcnt(2)
    v_fma_f32 v192, v192, s15, v216
    v_fma_f32 v193, v193, s15, v216
    v_mfma_f32_16x16x32_bf16 v[196:199], a[156:159], a[12:15], v[196:199]
    v_exp_f32 v192, v192
    v_smfmac_f32_16x16x64_bf16 a[232:235], a[252:255], v[208:215], v250
    v_exp_f32 v193, v193
    v_mfma_f32_16x16x32_bf16 v[160:163], a[160:163], v[212:215], v[160:163]
    v_fma_f32 v194, v194, s15, v216
    v_fma_f32 v195, v195, s15, v216
    v_mfma_f32_16x16x32_bf16 v[164:167], a[164:167], v[212:215], v[164:167]
    v_exp_f32 v194, v194
    v_mfma_f32_16x16x32_bf16 v[168:171], a[168:171], v[212:215], v[168:171]
    v_exp_f32 v195, v195
    v_mfma_f32_16x16x32_bf16 v[172:175], a[172:175], v[212:215], v[172:175]
    v_fma_f32 v196, v196, s15, v216
    v_cvt_pk_bf16_f32 v208, v192, v193
    v_mfma_f32_16x16x32_bf16 v[176:179], a[176:179], v[212:215], v[176:179]
    v_exp_f32 v196, v196
    v_mfma_f32_16x16x32_bf16 v[180:183], a[180:183], v[212:215], v[180:183]
    v_fma_f32 v197, v197, s15, v216
    v_fma_f32 v198, v198, s15, v216
    v_mfma_f32_16x16x32_bf16 v[184:187], a[184:187], v[212:215], v[184:187]
    v_exp_f32 v197, v197
    v_mfma_f32_16x16x32_bf16 v[188:191], a[188:191], v[212:215], v[188:191]
    ds_read_b64_tr_b16 a[196:197], v241 offset:4120
    v_cvt_pk_bf16_f32 v209, v194, v195
    v_mfma_f32_16x16x32_bf16 v[200:203], a[128:131], a[16:19], v[220:223]
    ds_read_b64_tr_b16 a[198:199], v241 offset:5144
    v_fma_f32 v199, v199, s15, v216
    v_mfma_f32_16x16x32_bf16 v[200:203], a[132:135], a[20:23], v[200:203]
    ds_read_b64_tr_b16 a[200:201], v241 offset:4368
    v_cvt_pk_bf16_f32 v210, v196, v197
    v_mfma_f32_16x16x32_bf16 v[200:203], a[136:139], a[24:27], v[200:203]
    ds_read_b64_tr_b16 a[202:203], v241 offset:5392
    ds_read_b64_tr_b16 a[204:205], v241 offset:4376
    v_mfma_f32_16x16x32_bf16 v[200:203], a[140:143], a[28:31], v[200:203]
    v_exp_f32 v198, v198
    v_mfma_f32_16x16x32_bf16 v[204:207], a[144:147], a[16:19], v[220:223]
    ds_read_b64_tr_b16 a[206:207], v241 offset:5400
    ds_read_b64_tr_b16 a[208:209], v241 offset:4624
    v_mfma_f32_16x16x32_bf16 v[204:207], a[148:151], a[20:23], v[204:207]
    ds_read_b64_tr_b16 a[210:211], v241 offset:5648
    v_exp_f32 v199, v199
    v_mfma_f32_16x16x32_bf16 v[204:207], a[152:155], a[24:27], v[204:207]
    ds_read_b64_tr_b16 a[212:213], v241 offset:4632
    ds_read_b64_tr_b16 a[214:215], v241 offset:5656
    v_cvt_pk_bf16_f32 v211, v198, v199
    v_mfma_f32_16x16x32_bf16 v[204:207], a[156:159], a[28:31], v[204:207]
    s_waitcnt lgkmcnt(8)
    ds_read_b64_tr_b16 a[216:217], v241 offset:4880
    ds_read_b64_tr_b16 a[218:219], v241 offset:5904
    v_mfma_f32_16x16x32_bf16 v[0:3], a[192:195], v[208:211], v[0:3]
    ds_read_b64_tr_b16 a[220:221], v241 offset:4888
    ds_read_b64_tr_b16 a[222:223], v241 offset:5912
    v_mfma_f32_16x16x32_bf16 v[4:7], a[196:199], v[208:211], v[4:7]
    s_waitcnt lgkmcnt(9)
    v_exp_f32 v200, v200
    v_mfma_f32_16x16x32_bf16 v[8:11], a[200:203], v[208:211], v[8:11]
    s_waitcnt lgkmcnt(8)
    v_exp_f32 v201, v201
    v_mfma_f32_16x16x32_bf16 v[12:15], a[204:207], v[208:211], v[12:15]
    s_waitcnt lgkmcnt(6)
    v_exp_f32 v202, v202
    v_mfma_f32_16x16x32_bf16 v[16:19], a[208:211], v[208:211], v[16:19]
    s_waitcnt lgkmcnt(4)
    v_exp_f32 v203, v203
    v_mfma_f32_16x16x32_bf16 v[20:23], a[212:215], v[208:211], v[20:23]
    s_waitcnt lgkmcnt(2)
    v_cvt_pk_bf16_f32 v212, v200, v201
    v_cvt_pk_bf16_f32 v213, v202, v203
    v_mfma_f32_16x16x32_bf16 v[24:27], a[216:219], v[208:211], v[24:27]
    s_waitcnt lgkmcnt(0)
    v_exp_f32 v204, v204
    v_mfma_f32_16x16x32_bf16 v[28:31], a[220:223], v[208:211], v[28:31]
    v_exp_f32 v205, v205
    v_mfma_f32_16x16x32_bf16 v[192:195], a[128:131], a[48:51], v[228:231]
    v_cvt_pk_bf16_f32 v214, v204, v205
    v_mfma_f32_16x16x32_bf16 v[192:195], a[132:135], a[52:55], v[192:195]
    v_exp_f32 v206, v206
    v_mfma_f32_16x16x32_bf16 v[192:195], a[136:139], a[56:59], v[192:195]
    v_exp_f32 v207, v207
    v_mfma_f32_16x16x32_bf16 v[192:195], a[140:143], a[60:63], v[192:195]
    v_cvt_pk_bf16_f32 v215, v206, v207
    v_mfma_f32_16x16x32_bf16 v[196:199], a[144:147], a[48:51], v[228:231]
    v_mfma_f32_16x16x32_bf16 v[196:199], a[148:151], a[52:55], v[196:199]
    v_mfma_f32_16x16x32_bf16 v[196:199], a[152:155], a[56:59], v[196:199]
    v_exp_f32 v192, v192
    v_mfma_f32_16x16x32_bf16 v[196:199], a[156:159], a[60:63], v[196:199]
    v_exp_f32 v193, v193
    v_smfmac_f32_16x16x64_bf16 a[224:227], a[252:255], v[208:215], v250
    v_exp_f32 v194, v194
    v_mfma_f32_16x16x32_bf16 v[32:35], a[192:195], v[212:215], v[32:35]
    v_exp_f32 v195, v195
    v_mfma_f32_16x16x32_bf16 v[36:39], a[196:199], v[212:215], v[36:39]
    v_cvt_pk_bf16_f32 v208, v192, v193
    v_cvt_pk_bf16_f32 v209, v194, v195
    v_mfma_f32_16x16x32_bf16 v[40:43], a[200:203], v[212:215], v[40:43]
    v_exp_f32 v196, v196
    v_mfma_f32_16x16x32_bf16 v[44:47], a[204:207], v[212:215], v[44:47]
    v_exp_f32 v197, v197
    v_mfma_f32_16x16x32_bf16 v[48:51], a[208:211], v[212:215], v[48:51]
    v_cvt_pk_bf16_f32 v210, v196, v197
    v_mfma_f32_16x16x32_bf16 v[52:55], a[212:215], v[212:215], v[52:55]
    v_exp_f32 v198, v198
    v_mfma_f32_16x16x32_bf16 v[56:59], a[216:219], v[212:215], v[56:59]
    v_exp_f32 v199, v199
    v_mfma_f32_16x16x32_bf16 v[60:63], a[220:223], v[212:215], v[60:63]
    s_add_u32 m0, s13, 12336
    s_mov_b32 s14, 40960
    v_cvt_pk_bf16_f32 v211, v198, v199
    v_mfma_f32_16x16x32_bf16 v[200:203], a[128:131], a[64:67], v[232:235]
    buffer_load_dwordx4 v244, s[20:23], s14 offen offset:0 nt lds
    v_mfma_f32_16x16x32_bf16 v[200:203], a[132:135], a[68:71], v[200:203]
    v_mfma_f32_16x16x32_bf16 v[200:203], a[136:139], a[72:75], v[200:203]
    v_mfma_f32_16x16x32_bf16 v[200:203], a[140:143], a[76:79], v[200:203]
    v_mfma_f32_16x16x32_bf16 v[204:207], a[144:147], a[64:67], v[232:235]
    buffer_load_dwordx4 v244, s[20:23], s14 offen offset:1024 nt lds
    v_mfma_f32_16x16x32_bf16 v[204:207], a[148:151], a[68:71], v[204:207]
    s_add_u32 m0, s92, 12336
    v_mfma_f32_16x16x32_bf16 v[204:207], a[152:155], a[72:75], v[204:207]
    v_exp_f32 v200, v200
    v_mfma_f32_16x16x32_bf16 v[204:207], a[156:159], a[76:79], v[204:207]
    v_exp_f32 v201, v201
    v_mfma_f32_16x16x32_bf16 v[96:99], a[192:195], v[208:211], v[96:99]
    buffer_load_dwordx4 v244, s[24:27], s14 offen offset:2048 nt lds
    v_mfma_f32_16x16x32_bf16 v[100:103], a[196:199], v[208:211], v[100:103]
    v_exp_f32 v202, v202
    v_mfma_f32_16x16x32_bf16 v[104:107], a[200:203], v[208:211], v[104:107]
    v_exp_f32 v203, v203
    v_mfma_f32_16x16x32_bf16 v[108:111], a[204:207], v[208:211], v[108:111]
    v_cvt_pk_bf16_f32 v212, v200, v201
    v_cvt_pk_bf16_f32 v213, v202, v203
    v_mfma_f32_16x16x32_bf16 v[112:115], a[208:211], v[208:211], v[112:115]
    buffer_load_dwordx4 v244, s[24:27], s14 offen offset:3072 nt lds
    v_mfma_f32_16x16x32_bf16 v[116:119], a[212:215], v[208:211], v[116:119]
    v_exp_f32 v204, v204
    v_mfma_f32_16x16x32_bf16 v[120:123], a[216:219], v[208:211], v[120:123]
    v_exp_f32 v205, v205
    v_mfma_f32_16x16x32_bf16 v[124:127], a[220:223], v[208:211], v[124:127]
    s_waitcnt vmcnt(4)
    s_barrier
    v_mfma_f32_16x16x32_bf16 v[192:195], a[128:131], a[32:35], v[224:227]
    ds_read_b128 a[96:99], v240 offset:8224
    v_cvt_pk_bf16_f32 v214, v204, v205
    v_mfma_f32_16x16x32_bf16 v[192:195], a[132:135], a[36:39], v[192:195]
    v_exp_f32 v206, v206
    v_mfma_f32_16x16x32_bf16 v[192:195], a[136:139], a[40:43], v[192:195]
    v_exp_f32 v207, v207
    v_mfma_f32_16x16x32_bf16 v[192:195], a[140:143], a[44:47], v[192:195]
    ds_read_b128 a[100:103], v240 offset:8480
    v_cvt_pk_bf16_f32 v215, v206, v207
    v_mfma_f32_16x16x32_bf16 v[196:199], a[144:147], a[32:35], v[224:227]
    ds_read_b64_tr_b16 a[160:161], v241 offset:8224
    v_mfma_f32_16x16x32_bf16 v[196:199], a[148:151], a[36:39], v[196:199]
    ds_read_b64_tr_b16 a[162:163], v241 offset:9248
    v_mfma_f32_16x16x32_bf16 v[196:199], a[152:155], a[40:43], v[196:199]
    v_exp_f32 v192, v192
    v_mfma_f32_16x16x32_bf16 v[196:199], a[156:159], a[44:47], v[196:199]
    v_exp_f32 v193, v193
    v_smfmac_f32_16x16x64_bf16 a[236:239], a[252:255], v[208:215], v250
    v_exp_f32 v194, v194
    v_mfma_f32_16x16x32_bf16 v[128:131], a[192:195], v[212:215], v[128:131]
    v_exp_f32 v195, v195
    v_mfma_f32_16x16x32_bf16 v[132:135], a[196:199], v[212:215], v[132:135]
    v_cvt_pk_bf16_f32 v208, v192, v193
    v_cvt_pk_bf16_f32 v209, v194, v195
    v_mfma_f32_16x16x32_bf16 v[136:139], a[200:203], v[212:215], v[136:139]
    v_exp_f32 v196, v196
    v_mfma_f32_16x16x32_bf16 v[140:143], a[204:207], v[212:215], v[140:143]
    v_exp_f32 v197, v197
    v_mfma_f32_16x16x32_bf16 v[144:147], a[208:211], v[212:215], v[144:147]
    ds_read_b128 a[104:107], v240 offset:8736
    v_cvt_pk_bf16_f32 v210, v196, v197
    v_mfma_f32_16x16x32_bf16 v[148:151], a[212:215], v[212:215], v[148:151]
    v_exp_f32 v198, v198
    v_mfma_f32_16x16x32_bf16 v[152:155], a[216:219], v[212:215], v[152:155]
    v_exp_f32 v199, v199
    v_mfma_f32_16x16x32_bf16 v[156:159], a[220:223], v[212:215], v[156:159]
    ds_read_b128 a[108:111], v240 offset:8992
    v_cvt_pk_bf16_f32 v211, v198, v199
    v_mfma_f32_16x16x32_bf16 v[200:203], a[128:131], a[80:83], v[236:239]
    ds_read_b64_tr_b16 a[164:165], v241 offset:8232
    v_mfma_f32_16x16x32_bf16 v[200:203], a[132:135], a[84:87], v[200:203]
    ds_read_b64_tr_b16 a[166:167], v241 offset:9256
    v_mfma_f32_16x16x32_bf16 v[200:203], a[136:139], a[88:91], v[200:203]
    ds_read_b64_tr_b16 a[168:169], v241 offset:8480
    v_mfma_f32_16x16x32_bf16 v[200:203], a[140:143], a[92:95], v[200:203]
    ds_read_b128 a[112:115], v240 offset:9248
    v_mfma_f32_16x16x32_bf16 v[204:207], a[144:147], a[80:83], v[236:239]
    ds_read_b64_tr_b16 a[170:171], v241 offset:9504
    v_mfma_f32_16x16x32_bf16 v[204:207], a[148:151], a[84:87], v[204:207]
    ds_read_b64_tr_b16 a[172:173], v241 offset:8488
    v_mfma_f32_16x16x32_bf16 v[204:207], a[152:155], a[88:91], v[204:207]
    v_exp_f32 v200, v200
    v_mfma_f32_16x16x32_bf16 v[204:207], a[156:159], a[92:95], v[204:207]
    v_exp_f32 v201, v201
    v_mfma_f32_16x16x32_bf16 v[64:67], a[192:195], v[208:211], v[64:67]
    v_exp_f32 v202, v202
    v_mfma_f32_16x16x32_bf16 v[68:71], a[196:199], v[208:211], v[68:71]
    v_exp_f32 v203, v203
    v_mfma_f32_16x16x32_bf16 v[72:75], a[200:203], v[208:211], v[72:75]
    ds_read_b128 a[116:119], v240 offset:9504
    v_cvt_pk_bf16_f32 v212, v200, v201
    v_mfma_f32_16x16x32_bf16 v[76:79], a[204:207], v[208:211], v[76:79]
    v_exp_f32 v204, v204
    v_mfma_f32_16x16x32_bf16 v[80:83], a[208:211], v[208:211], v[80:83]
    ds_read_b128 a[120:123], v240 offset:9760
    v_cvt_pk_bf16_f32 v213, v202, v203
    v_mfma_f32_16x16x32_bf16 v[84:87], a[212:215], v[208:211], v[84:87]
    v_exp_f32 v205, v205
    v_mfma_f32_16x16x32_bf16 v[88:91], a[216:219], v[208:211], v[88:91]
    ds_read_b128 a[124:127], v240 offset:10016
    v_cvt_pk_bf16_f32 v214, v204, v205
    v_mfma_f32_16x16x32_bf16 v[92:95], a[220:223], v[208:211], v[92:95]
    s_waitcnt lgkmcnt(3)
    v_exp_f32 v206, v206
    v_mfma_f32_16x16x32_bf16 v[192:195], a[96:99], a[0:3], 0
    v_exp_f32 v207, v207
    v_mfma_f32_16x16x32_bf16 v[192:195], a[100:103], a[4:7], v[192:195]
    ds_read_b64_tr_b16 a[174:175], v241 offset:9512
    v_cvt_pk_bf16_f32 v215, v206, v207
    v_mfma_f32_16x16x32_bf16 v[192:195], a[104:107], a[8:11], v[192:195]
    ds_read_b64_tr_b16 a[176:177], v241 offset:8736
    ds_read_b64_tr_b16 a[178:179], v241 offset:9760
    v_mfma_f32_16x16x32_bf16 v[192:195], a[108:111], a[12:15], v[192:195]
    ds_read_b64_tr_b16 a[180:181], v241 offset:8744
    v_mfma_f32_16x16x32_bf16 v[196:199], a[112:115], a[0:3], 0
    s_waitcnt lgkmcnt(5)
    ds_read_b64_tr_b16 a[182:183], v241 offset:9768
    v_mfma_f32_16x16x32_bf16 v[196:199], a[116:119], a[4:7], v[196:199]
    ds_read_b64_tr_b16 a[184:185], v241 offset:8992
    v_mfma_f32_16x16x32_bf16 v[196:199], a[120:123], a[8:11], v[196:199]
    s_waitcnt lgkmcnt(6)
    v_fma_f32 v192, v192, s15, v216
    v_fma_f32 v193, v193, s15, v216
    v_mfma_f32_16x16x32_bf16 v[196:199], a[124:127], a[12:15], v[196:199]
    v_exp_f32 v192, v192
    v_smfmac_f32_16x16x64_bf16 a[232:235], a[252:255], v[208:215], v250
    v_exp_f32 v193, v193
    v_mfma_f32_16x16x32_bf16 v[160:163], a[192:195], v[212:215], v[160:163]
    v_fma_f32 v194, v194, s15, v216
    v_fma_f32 v195, v195, s15, v216
    v_mfma_f32_16x16x32_bf16 v[164:167], a[196:199], v[212:215], v[164:167]
    v_exp_f32 v194, v194
    v_mfma_f32_16x16x32_bf16 v[168:171], a[200:203], v[212:215], v[168:171]
    v_exp_f32 v195, v195
    v_mfma_f32_16x16x32_bf16 v[172:175], a[204:207], v[212:215], v[172:175]
    v_fma_f32 v196, v196, s15, v216
    v_cvt_pk_bf16_f32 v208, v192, v193
    v_mfma_f32_16x16x32_bf16 v[176:179], a[208:211], v[212:215], v[176:179]
    v_exp_f32 v196, v196
    v_mfma_f32_16x16x32_bf16 v[180:183], a[212:215], v[212:215], v[180:183]
L_pad3:
    s_cbranch_execz L_warm
    v_fma_f32 v197, v197, s15, v216
    v_fma_f32 v198, v198, s15, v216
    v_mfma_f32_16x16x32_bf16 v[184:187], a[216:219], v[212:215], v[184:187]
    v_exp_f32 v197, v197
    v_mfma_f32_16x16x32_bf16 v[188:191], a[220:223], v[212:215], v[188:191]
    s_add_u32 m0, s13, 0
    s_mov_b32 s14, 49152
    v_cvt_pk_bf16_f32 v209, v194, v195
    v_mfma_f32_16x16x32_bf16 v[200:203], a[96:99], a[16:19], v[220:223]
    buffer_load_dwordx4 v244, s[20:23], s14 offen offset:0 nt lds
    v_mfma_f32_16x16x32_bf16 v[200:203], a[100:103], a[20:23], v[200:203]
    v_fma_f32 v199, v199, s15, v216
    v_cvt_pk_bf16_f32 v210, v196, v197
    v_mfma_f32_16x16x32_bf16 v[200:203], a[104:107], a[24:27], v[200:203]
    v_exp_f32 v198, v198
    v_mfma_f32_16x16x32_bf16 v[200:203], a[108:111], a[28:31], v[200:203]
    v_exp_f32 v199, v199
    v_mfma_f32_16x16x32_bf16 v[204:207], a[112:115], a[16:19], v[220:223]
    buffer_load_dwordx4 v244, s[20:23], s14 offen offset:1024 nt lds
    v_mfma_f32_16x16x32_bf16 v[204:207], a[116:119], a[20:23], v[204:207]
    s_add_u32 m0, s92, 0
    ds_read_b64_tr_b16 a[186:187], v241 offset:10016
    v_cvt_pk_bf16_f32 v211, v198, v199
    v_mfma_f32_16x16x32_bf16 v[204:207], a[120:123], a[24:27], v[204:207]
    ds_read_b64_tr_b16 a[188:189], v241 offset:9000
    ds_read_b64_tr_b16 a[190:191], v241 offset:10024
    v_mfma_f32_16x16x32_bf16 v[204:207], a[124:127], a[28:31], v[204:207]
    v_exp_f32 v200, v200
    v_mfma_f32_16x16x32_bf16 v[0:3], a[160:163], v[208:211], v[0:3]
    buffer_load_dwordx4 v244, s[24:27], s14 offen offset:2048 nt lds
    v_mfma_f32_16x16x32_bf16 v[4:7], a[164:167], v[208:211], v[4:7]
    v_exp_f32 v201, v201
    v_mfma_f32_16x16x32_bf16 v[8:11], a[168:171], v[208:211], v[8:11]
    s_waitcnt lgkmcnt(3)
    v_exp_f32 v202, v202
    v_mfma_f32_16x16x32_bf16 v[12:15], a[172:175], v[208:211], v[12:15]
    v_exp_f32 v203, v203
    v_mfma_f32_16x16x32_bf16 v[16:19], a[176:179], v[208:211], v[16:19]
    buffer_load_dwordx4 v244, s[24:27], s14 offen offset:3072 nt lds
    v_mfma_f32_16x16x32_bf16 v[20:23], a[180:183], v[208:211], v[20:23]
    s_waitcnt lgkmcnt(2)
    v_cvt_pk_bf16_f32 v212, v200, v201
    v_cvt_pk_bf16_f32 v213, v202, v203
    v_mfma_f32_16x16x32_bf16 v[24:27], a[184:187], v[208:211], v[24:27]
    s_waitcnt lgkmcnt(0)
    v_exp_f32 v204, v204
    v_mfma_f32_16x16x32_bf16 v[28:31], a[188:191], v[208:211], v[28:31]
    v_exp_f32 v205, v205
    v_mfma_f32_16x16x32_bf16 v[192:195], a[96:99], a[48:51], v[228:231]
    v_cvt_pk_bf16_f32 v214, v204, v205
    v_mfma_f32_16x16x32_bf16 v[192:195], a[100:103], a[52:55], v[192:195]
    v_exp_f32 v206, v206
    v_mfma_f32_16x16x32_bf16 v[192:195], a[104:107], a[56:59], v[192:195]
    v_exp_f32 v207, v207
    v_mfma_f32_16x16x32_bf16 v[192:195], a[108:111], a[60:63], v[192:195]
    v_cvt_pk_bf16_f32 v215, v206, v207
    v_mfma_f32_16x16x32_bf16 v[196:199], a[112:115], a[48:51], v[228:231]
    v_mfma_f32_16x16x32_bf16 v[196:199], a[116:119], a[52:55], v[196:199]
    v_mfma_f32_16x16x32_bf16 v[196:199], a[120:123], a[56:59], v[196:199]
    v_exp_f32 v192, v192
    v_mfma_f32_16x16x32_bf16 v[196:199], a[124:127], a[60:63], v[196:199]
    v_exp_f32 v193, v193
    v_smfmac_f32_16x16x64_bf16 a[224:227], a[252:255], v[208:215], v250
    v_exp_f32 v194, v194
    v_mfma_f32_16x16x32_bf16 v[32:35], a[160:163], v[212:215], v[32:35]
    v_exp_f32 v195, v195
    v_mfma_f32_16x16x32_bf16 v[36:39], a[164:167], v[212:215], v[36:39]
    v_cvt_pk_bf16_f32 v208, v192, v193
    v_cvt_pk_bf16_f32 v209, v194, v195
    v_mfma_f32_16x16x32_bf16 v[40:43], a[168:171], v[212:215], v[40:43]
    v_exp_f32 v196, v196
    v_mfma_f32_16x16x32_bf16 v[44:47], a[172:175], v[212:215], v[44:47]
    v_exp_f32 v197, v197
    v_mfma_f32_16x16x32_bf16 v[48:51], a[176:179], v[212:215], v[48:51]
    v_cvt_pk_bf16_f32 v210, v196, v197
    v_mfma_f32_16x16x32_bf16 v[52:55], a[180:183], v[212:215], v[52:55]
    v_exp_f32 v198, v198
    v_mfma_f32_16x16x32_bf16 v[56:59], a[184:187], v[212:215], v[56:59]
    v_exp_f32 v199, v199
    v_mfma_f32_16x16x32_bf16 v[60:63], a[188:191], v[212:215], v[60:63]
    v_cvt_pk_bf16_f32 v211, v198, v199
    v_mfma_f32_16x16x32_bf16 v[200:203], a[96:99], a[64:67], v[232:235]
    v_mfma_f32_16x16x32_bf16 v[200:203], a[100:103], a[68:71], v[200:203]
    v_mfma_f32_16x16x32_bf16 v[200:203], a[104:107], a[72:75], v[200:203]
    v_mfma_f32_16x16x32_bf16 v[200:203], a[108:111], a[76:79], v[200:203]
    v_mfma_f32_16x16x32_bf16 v[204:207], a[112:115], a[64:67], v[232:235]
    v_mfma_f32_16x16x32_bf16 v[204:207], a[116:119], a[68:71], v[204:207]
    v_mfma_f32_16x16x32_bf16 v[204:207], a[120:123], a[72:75], v[204:207]
    v_exp_f32 v200, v200
    v_mfma_f32_16x16x32_bf16 v[204:207], a[124:127], a[76:79], v[204:207]
    v_exp_f32 v201, v201
    v_mfma_f32_16x16x32_bf16 v[96:99], a[160:163], v[208:211], v[96:99]
    v_exp_f32 v202, v202
    v_mfma_f32_16x16x32_bf16 v[100:103], a[164:167], v[208:211], v[100:103]
    v_exp_f32 v203, v203
    v_mfma_f32_16x16x32_bf16 v[104:107], a[168:171], v[208:211], v[104:107]
    v_cvt_pk_bf16_f32 v212, v200, v201
    v_cvt_pk_bf16_f32 v213, v202, v203
    v_mfma_f32_16x16x32_bf16 v[108:111], a[172:175], v[208:211], v[108:111]
    v_exp_f32 v204, v204
    v_mfma_f32_16x16x32_bf16 v[112:115], a[176:179], v[208:211], v[112:115]
    v_exp_f32 v205, v205
    v_mfma_f32_16x16x32_bf16 v[116:119], a[180:183], v[208:211], v[116:119]
    v_cvt_pk_bf16_f32 v214, v204, v205
    v_mfma_f32_16x16x32_bf16 v[120:123], a[184:187], v[208:211], v[120:123]
    v_exp_f32 v206, v206
    v_mfma_f32_16x16x32_bf16 v[124:127], a[188:191], v[208:211], v[124:127]
    s_waitcnt vmcnt(4)
    s_barrier
    v_mfma_f32_16x16x32_bf16 v[192:195], a[96:99], a[32:35], v[224:227]
    v_exp_f32 v207, v207
    v_mfma_f32_16x16x32_bf16 v[192:195], a[100:103], a[36:39], v[192:195]
    ds_read_b128 a[128:131], v240 offset:12336
    v_cvt_pk_bf16_f32 v215, v206, v207
    v_mfma_f32_16x16x32_bf16 v[192:195], a[104:107], a[40:43], v[192:195]
    ds_read_b64_tr_b16 a[192:193], v241 offset:12336
    v_mfma_f32_16x16x32_bf16 v[192:195], a[108:111], a[44:47], v[192:195]
    ds_read_b64_tr_b16 a[194:195], v241 offset:13360
    v_mfma_f32_16x16x32_bf16 v[196:199], a[112:115], a[32:35], v[224:227]
    ds_read_b64_tr_b16 a[196:197], v241 offset:12344
    v_mfma_f32_16x16x32_bf16 v[196:199], a[116:119], a[36:39], v[196:199]
    ds_read_b128 a[132:135], v240 offset:12592
    v_mfma_f32_16x16x32_bf16 v[196:199], a[120:123], a[40:43], v[196:199]
    v_exp_f32 v192, v192
    v_mfma_f32_16x16x32_bf16 v[196:199], a[124:127], a[44:47], v[196:199]
    v_exp_f32 v193, v193
    v_smfmac_f32_16x16x64_bf16 a[236:239], a[252:255], v[208:215], v250
    v_exp_f32 v194, v194
    v_mfma_f32_16x16x32_bf16 v[128:131], a[160:163], v[212:215], v[128:131]
    v_exp_f32 v195, v195
    v_mfma_f32_16x16x32_bf16 v[132:135], a[164:167], v[212:215], v[132:135]
    v_cvt_pk_bf16_f32 v208, v192, v193
    v_cvt_pk_bf16_f32 v209, v194, v195
    v_mfma_f32_16x16x32_bf16 v[136:139], a[168:171], v[212:215], v[136:139]
    v_exp_f32 v196, v196
    v_mfma_f32_16x16x32_bf16 v[140:143], a[172:175], v[212:215], v[140:143]
    v_exp_f32 v197, v197
    v_mfma_f32_16x16x32_bf16 v[144:147], a[176:179], v[212:215], v[144:147]
    ds_read_b128 a[136:139], v240 offset:12848
    v_cvt_pk_bf16_f32 v210, v196, v197
    v_mfma_f32_16x16x32_bf16 v[148:151], a[180:183], v[212:215], v[148:151]
    v_exp_f32 v198, v198
    v_mfma_f32_16x16x32_bf16 v[152:155], a[184:187], v[212:215], v[152:155]
    v_exp_f32 v199, v199
    v_mfma_f32_16x16x32_bf16 v[156:159], a[188:191], v[212:215], v[156:159]
    s_add_u32 m0, s13, 4112
    s_mov_b32 s14, 57344
    v_cvt_pk_bf16_f32 v211, v198, v199
    v_mfma_f32_16x16x32_bf16 v[200:203], a[96:99], a[80:83], v[236:239]
    buffer_load_dwordx4 v244, s[20:23], s14 offen offset:0 nt lds
    v_mfma_f32_16x16x32_bf16 v[200:203], a[100:103], a[84:87], v[200:203]
    ds_read_b128 a[140:143], v240 offset:13104
    v_mfma_f32_16x16x32_bf16 v[200:203], a[104:107], a[88:91], v[200:203]
    ds_read_b64_tr_b16 a[198:199], v241 offset:13368
    v_mfma_f32_16x16x32_bf16 v[200:203], a[108:111], a[92:95], v[200:203]
    ds_read_b64_tr_b16 a[200:201], v241 offset:12592
    v_mfma_f32_16x16x32_bf16 v[204:207], a[112:115], a[80:83], v[236:239]
    buffer_load_dwordx4 v244, s[20:23], s14 offen offset:1024 nt lds
    v_mfma_f32_16x16x32_bf16 v[204:207], a[116:119], a[84:87], v[204:207]
    s_add_u32 m0, s92, 4112
    ds_read_b128 a[144:147], v240 offset:13360
    v_mfma_f32_16x16x32_bf16 v[204:207], a[120:123], a[88:91], v[204:207]
    v_exp_f32 v200, v200
    v_mfma_f32_16x16x32_bf16 v[204:207], a[124:127], a[92:95], v[204:207]
    v_exp_f32 v201, v201
    v_mfma_f32_16x16x32_bf16 v[64:67], a[160:163], v[208:211], v[64:67]
    buffer_load_dwordx4 v244, s[24:27], s14 offen offset:2048 nt lds
    v_mfma_f32_16x16x32_bf16 v[68:71], a[164:167], v[208:211], v[68:71]
    v_exp_f32 v202, v202
    v_mfma_f32_16x16x32_bf16 v[72:75], a[168:171], v[208:211], v[72:75]
    v_exp_f32 v203, v203
    v_mfma_f32_16x16x32_bf16 v[76:79], a[172:175], v[208:211], v[76:79]
    ds_read_b128 a[148:151], v240 offset:13616
    v_cvt_pk_bf16_f32 v212, v200, v201
    v_mfma_f32_16x16x32_bf16 v[80:83], a[176:179], v[208:211], v[80:83]
    buffer_load_dwordx4 v244, s[24:27], s14 offen offset:3072 nt lds
    v_mfma_f32_16x16x32_bf16 v[84:87], a[180:183], v[208:211], v[84:87]
    ds_read_b128 a[152:155], v240 offset:13872
    v_cvt_pk_bf16_f32 v213, v202, v203
    v_mfma_f32_16x16x32_bf16 v[88:91], a[184:187], v[208:211], v[88:91]
    v_exp_f32 v204, v204
    v_mfma_f32_16x16x32_bf16 v[92:95], a[188:191], v[208:211], v[92:95]
    s_waitcnt lgkmcnt(2)
    ds_read_b128 a[156:159], v240 offset:14128
    v_mfma_f32_16x16x32_bf16 v[192:195], a[128:131], a[0:3], 0
    v_exp_f32 v205, v205
    v_mfma_f32_16x16x32_bf16 v[192:195], a[132:135], a[4:7], v[192:195]
    ds_read_b64_tr_b16 a[202:203], v241 offset:13616
    v_cvt_pk_bf16_f32 v214, v204, v205
    v_mfma_f32_16x16x32_bf16 v[192:195], a[136:139], a[8:11], v[192:195]
    v_exp_f32 v206, v206
    v_mfma_f32_16x16x32_bf16 v[192:195], a[140:143], a[12:15], v[192:195]
    v_exp_f32 v207, v207
    v_mfma_f32_16x16x32_bf16 v[196:199], a[144:147], a[0:3], 0
    s_waitcnt lgkmcnt(3)
    ds_read_b64_tr_b16 a[204:205], v241 offset:12600
    v_cvt_pk_bf16_f32 v215, v206, v207
    v_mfma_f32_16x16x32_bf16 v[196:199], a[148:151], a[4:7], v[196:199]
    s_waitcnt lgkmcnt(3)
    ds_read_b64_tr_b16 a[206:207], v241 offset:13624
    ds_read_b64_tr_b16 a[208:209], v241 offset:12848
    v_mfma_f32_16x16x32_bf16 v[196:199], a[152:155], a[8:11], v[196:199]
    s_waitcnt lgkmcnt(4)
    v_fma_f32 v192, v192, s15, v216
    v_fma_f32 v193, v193, s15, v216
    v_mfma_f32_16x16x32_bf16 v[196:199], a[156:159], a[12:15], v[196:199]
    v_exp_f32 v192, v192
    v_smfmac_f32_16x16x64_bf16 a[232:235], a[252:255], v[208:215], v250
    v_exp_f32 v193, v193
    v_mfma_f32_16x16x32_bf16 v[160:163], a[160:163], v[212:215], v[160:163]
    v_fma_f32 v194, v194, s15, v216
    v_fma_f32 v195, v195, s15, v216
    v_mfma_f32_16x16x32_bf16 v[164:167], a[164:167], v[212:215], v[164:167]
    v_exp_f32 v194, v194
    v_mfma_f32_16x16x32_bf16 v[168:171], a[168:171], v[212:215], v[168:171]
    v_exp_f32 v195, v195
    v_mfma_f32_16x16x32_bf16 v[172:175], a[172:175], v[212:215], v[172:175]
    v_fma_f32 v196, v196, s15, v216
    v_cvt_pk_bf16_f32 v208, v192, v193
    v_mfma_f32_16x16x32_bf16 v[176:179], a[176:179], v[212:215], v[176:179]
    v_exp_f32 v196, v196
    v_mfma_f32_16x16x32_bf16 v[180:183], a[180:183], v[212:215], v[180:183]
    v_fma_f32 v197, v197, s15, v216
    v_fma_f32 v198, v198, s15, v216
    v_mfma_f32_16x16x32_bf16 v[184:187], a[184:187], v[212:215], v[184:187]
    v_exp_f32 v197, v197
    v_mfma_f32_16x16x32_bf16 v[188:191], a[188:191], v[212:215], v[188:191]
    v_cvt_pk_bf16_f32 v209, v194, v195
    v_fma_f32 v199, v199, s15, v216
    v_mfma_f32_16x16x32_bf16 v[200:203], a[128:131], a[16:19], v[220:223]
    ds_read_b64_tr_b16 a[210:211], v241 offset:13872
    v_cvt_pk_bf16_f32 v210, v196, v197
    v_mfma_f32_16x16x32_bf16 v[200:203], a[132:135], a[20:23], v[200:203]
    v_exp_f32 v198, v198
    v_mfma_f32_16x16x32_bf16 v[200:203], a[136:139], a[24:27], v[200:203]
    v_exp_f32 v199, v199
    v_mfma_f32_16x16x32_bf16 v[200:203], a[140:143], a[28:31], v[200:203]
    ds_read_b64_tr_b16 a[212:213], v241 offset:12856
    v_cvt_pk_bf16_f32 v211, v198, v199
    v_mfma_f32_16x16x32_bf16 v[204:207], a[144:147], a[16:19], v[220:223]
    ds_read_b64_tr_b16 a[214:215], v241 offset:13880
    ds_read_b64_tr_b16 a[216:217], v241 offset:13104
    v_mfma_f32_16x16x32_bf16 v[204:207], a[148:151], a[20:23], v[204:207]
    ds_read_b64_tr_b16 a[218:219], v241 offset:14128
    v_mfma_f32_16x16x32_bf16 v[204:207], a[152:155], a[24:27], v[204:207]
    ds_read_b64_tr_b16 a[220:221], v241 offset:13112
    v_mfma_f32_16x16x32_bf16 v[204:207], a[156:159], a[28:31], v[204:207]
    ds_read_b64_tr_b16 a[222:223], v241 offset:14136
    v_mfma_f32_16x16x32_bf16 v[0:3], a[192:195], v[208:211], v[0:3]
    v_exp_f32 v200, v200
    v_mfma_f32_16x16x32_bf16 v[4:7], a[196:199], v[208:211], v[4:7]
    s_waitcnt lgkmcnt(6)
    v_exp_f32 v201, v201
    v_mfma_f32_16x16x32_bf16 v[8:11], a[200:203], v[208:211], v[8:11]
    v_exp_f32 v202, v202
    v_mfma_f32_16x16x32_bf16 v[12:15], a[204:207], v[208:211], v[12:15]
    v_exp_f32 v203, v203
    v_mfma_f32_16x16x32_bf16 v[16:19], a[208:211], v[208:211], v[16:19]
    s_waitcnt lgkmcnt(4)
    v_cvt_pk_bf16_f32 v212, v200, v201
    v_cvt_pk_bf16_f32 v213, v202, v203
    v_mfma_f32_16x16x32_bf16 v[20:23], a[212:215], v[208:211], v[20:23]
    s_waitcnt lgkmcnt(2)
    v_exp_f32 v204, v204
    v_mfma_f32_16x16x32_bf16 v[24:27], a[216:219], v[208:211], v[24:27]
    s_waitcnt lgkmcnt(0)
    v_exp_f32 v205, v205
    v_mfma_f32_16x16x32_bf16 v[28:31], a[220:223], v[208:211], v[28:31]
    s_add_u32 m0, s13, 16448
    s_mov_b32 s14, 65536
    v_cvt_pk_bf16_f32 v214, v204, v205
    v_mfma_f32_16x16x32_bf16 v[192:195], a[128:131], a[48:51], v[228:231]
    buffer_load_dwordx4 v244, s[20:23], s14 offen offset:0 nt lds
    v_mfma_f32_16x16x32_bf16 v[192:195], a[132:135], a[52:55], v[192:195]
    v_exp_f32 v206, v206
    v_mfma_f32_16x16x32_bf16 v[192:195], a[136:139], a[56:59], v[192:195]
    v_exp_f32 v207, v207
    v_mfma_f32_16x16x32_bf16 v[192:195], a[140:143], a[60:63], v[192:195]
    v_cvt_pk_bf16_f32 v215, v206, v207
    v_mfma_f32_16x16x32_bf16 v[196:199], a[144:147], a[48:51], v[228:231]
    buffer_load_dwordx4 v244, s[20:23], s14 offen offset:1024 nt lds
    v_mfma_f32_16x16x32_bf16 v[196:199], a[148:151], a[52:55], v[196:199]
    s_add_u32 m0, s92, 16448
    v_mfma_f32_16x16x32_bf16 v[196:199], a[152:155], a[56:59], v[196:199]
    v_exp_f32 v192, v192
    v_mfma_f32_16x16x32_bf16 v[196:199], a[156:159], a[60:63], v[196:199]
    v_exp_f32 v193, v193
    v_smfmac_f32_16x16x64_bf16 a[224:227], a[252:255], v[208:215], v250
    buffer_load_dwordx4 v244, s[24:27], s14 offen offset:2048 nt lds
    v_mfma_f32_16x16x32_bf16 v[32:35], a[192:195], v[212:215], v[32:35]
    v_exp_f32 v194, v194
    v_mfma_f32_16x16x32_bf16 v[36:39], a[196:199], v[212:215], v[36:39]
    v_exp_f32 v195, v195
    v_mfma_f32_16x16x32_bf16 v[40:43], a[200:203], v[212:215], v[40:43]
    v_cvt_pk_bf16_f32 v208, v192, v193
    v_cvt_pk_bf16_f32 v209, v194, v195
    v_mfma_f32_16x16x32_bf16 v[44:47], a[204:207], v[212:215], v[44:47]
    buffer_load_dwordx4 v244, s[24:27], s14 offen offset:3072 nt lds
    v_mfma_f32_16x16x32_bf16 v[48:51], a[208:211], v[212:215], v[48:51]
    v_exp_f32 v196, v196
    v_mfma_f32_16x16x32_bf16 v[52:55], a[212:215], v[212:215], v[52:55]
    v_exp_f32 v197, v197
    v_mfma_f32_16x16x32_bf16 v[56:59], a[216:219], v[212:215], v[56:59]
    v_cvt_pk_bf16_f32 v210, v196, v197
    v_mfma_f32_16x16x32_bf16 v[60:63], a[220:223], v[212:215], v[60:63]
    v_exp_f32 v198, v198
    v_mfma_f32_16x16x32_bf16 v[200:203], a[128:131], a[64:67], v[232:235]
    v_exp_f32 v199, v199
    v_mfma_f32_16x16x32_bf16 v[200:203], a[132:135], a[68:71], v[200:203]
    v_cvt_pk_bf16_f32 v211, v198, v199
    v_mfma_f32_16x16x32_bf16 v[200:203], a[136:139], a[72:75], v[200:203]
    v_mfma_f32_16x16x32_bf16 v[200:203], a[140:143], a[76:79], v[200:203]
    v_mfma_f32_16x16x32_bf16 v[204:207], a[144:147], a[64:67], v[232:235]
    v_mfma_f32_16x16x32_bf16 v[204:207], a[148:151], a[68:71], v[204:207]
    v_mfma_f32_16x16x32_bf16 v[204:207], a[152:155], a[72:75], v[204:207]
    v_exp_f32 v200, v200
    v_mfma_f32_16x16x32_bf16 v[204:207], a[156:159], a[76:79], v[204:207]
    v_exp_f32 v201, v201
    v_mfma_f32_16x16x32_bf16 v[96:99], a[192:195], v[208:211], v[96:99]
    v_exp_f32 v202, v202
    v_mfma_f32_16x16x32_bf16 v[100:103], a[196:199], v[208:211], v[100:103]
    v_exp_f32 v203, v203
    v_mfma_f32_16x16x32_bf16 v[104:107], a[200:203], v[208:211], v[104:107]
    v_cvt_pk_bf16_f32 v212, v200, v201
    v_cvt_pk_bf16_f32 v213, v202, v203
    v_mfma_f32_16x16x32_bf16 v[108:111], a[204:207], v[208:211], v[108:111]
    v_exp_f32 v204, v204
    v_mfma_f32_16x16x32_bf16 v[112:115], a[208:211], v[208:211], v[112:115]
    v_exp_f32 v205, v205
    v_mfma_f32_16x16x32_bf16 v[116:119], a[212:215], v[208:211], v[116:119]
    v_cvt_pk_bf16_f32 v214, v204, v205
    v_mfma_f32_16x16x32_bf16 v[120:123], a[216:219], v[208:211], v[120:123]
    v_exp_f32 v206, v206
    v_mfma_f32_16x16x32_bf16 v[124:127], a[220:223], v[208:211], v[124:127]
    s_waitcnt vmcnt(8)
    s_barrier
    v_mfma_f32_16x16x32_bf16 v[192:195], a[128:131], a[32:35], v[224:227]
    v_exp_f32 v207, v207
    v_mfma_f32_16x16x32_bf16 v[192:195], a[132:135], a[36:39], v[192:195]
    ds_read_b128 a[96:99], v240 offset:0
    v_cvt_pk_bf16_f32 v215, v206, v207
    v_mfma_f32_16x16x32_bf16 v[192:195], a[136:139], a[40:43], v[192:195]
    ds_read_b64_tr_b16 a[160:161], v241 offset:0
    v_mfma_f32_16x16x32_bf16 v[192:195], a[140:143], a[44:47], v[192:195]
    ds_read_b64_tr_b16 a[162:163], v241 offset:1024
    v_mfma_f32_16x16x32_bf16 v[196:199], a[144:147], a[32:35], v[224:227]
    ds_read_b64_tr_b16 a[164:165], v241 offset:8
    v_mfma_f32_16x16x32_bf16 v[196:199], a[148:151], a[36:39], v[196:199]
    ds_read_b128 a[100:103], v240 offset:256
    v_mfma_f32_16x16x32_bf16 v[196:199], a[152:155], a[40:43], v[196:199]
    v_exp_f32 v192, v192
    v_mfma_f32_16x16x32_bf16 v[196:199], a[156:159], a[44:47], v[196:199]
    v_exp_f32 v193, v193
    v_smfmac_f32_16x16x64_bf16 a[236:239], a[252:255], v[208:215], v250
    v_exp_f32 v194, v194
    v_mfma_f32_16x16x32_bf16 v[128:131], a[192:195], v[212:215], v[128:131]
    v_exp_f32 v195, v195
    v_mfma_f32_16x16x32_bf16 v[132:135], a[196:199], v[212:215], v[132:135]
    v_cvt_pk_bf16_f32 v208, v192, v193
    v_cvt_pk_bf16_f32 v209, v194, v195
    v_mfma_f32_16x16x32_bf16 v[136:139], a[200:203], v[212:215], v[136:139]
    v_exp_f32 v196, v196
    v_mfma_f32_16x16x32_bf16 v[140:143], a[204:207], v[212:215], v[140:143]
    v_exp_f32 v197, v197
    v_mfma_f32_16x16x32_bf16 v[144:147], a[208:211], v[212:215], v[144:147]
    ds_read_b128 a[104:107], v240 offset:512
    v_cvt_pk_bf16_f32 v210, v196, v197
    v_mfma_f32_16x16x32_bf16 v[148:151], a[212:215], v[212:215], v[148:151]
    v_exp_f32 v198, v198
    v_mfma_f32_16x16x32_bf16 v[152:155], a[216:219], v[212:215], v[152:155]
    v_exp_f32 v199, v199
    v_mfma_f32_16x16x32_bf16 v[156:159], a[220:223], v[212:215], v[156:159]
    s_add_u32 m0, s13, 8224
    s_mov_b32 s14, 73728
    v_cvt_pk_bf16_f32 v211, v198, v199
    v_mfma_f32_16x16x32_bf16 v[200:203], a[128:131], a[80:83], v[236:239]
    buffer_load_dwordx4 v244, s[20:23], s14 offen offset:0 nt lds
    v_mfma_f32_16x16x32_bf16 v[200:203], a[132:135], a[84:87], v[200:203]
    ds_read_b128 a[108:111], v240 offset:768
    v_mfma_f32_16x16x32_bf16 v[200:203], a[136:139], a[88:91], v[200:203]
    ds_read_b64_tr_b16 a[166:167], v241 offset:1032
    v_mfma_f32_16x16x32_bf16 v[200:203], a[140:143], a[92:95], v[200:203]
    ds_read_b64_tr_b16 a[168:169], v241 offset:256
    v_mfma_f32_16x16x32_bf16 v[204:207], a[144:147], a[80:83], v[236:239]
    buffer_load_dwordx4 v244, s[20:23], s14 offen offset:1024 nt lds
    v_mfma_f32_16x16x32_bf16 v[204:207], a[148:151], a[84:87], v[204:207]
    s_add_u32 m0, s92, 8224
    ds_read_b128 a[112:115], v240 offset:1024
    v_mfma_f32_16x16x32_bf16 v[204:207], a[152:155], a[88:91], v[204:207]
    v_exp_f32 v200, v200
    v_mfma_f32_16x16x32_bf16 v[204:207], a[156:159], a[92:95], v[204:207]
    v_exp_f32 v201, v201
    v_mfma_f32_16x16x32_bf16 v[64:67], a[192:195], v[208:211], v[64:67]
    buffer_load_dwordx4 v244, s[24:27], s14 offen offset:2048 nt lds
    v_mfma_f32_16x16x32_bf16 v[68:71], a[196:199], v[208:211], v[68:71]
    v_exp_f32 v202, v202
    v_mfma_f32_16x16x32_bf16 v[72:75], a[200:203], v[208:211], v[72:75]
    v_exp_f32 v203, v203
    v_mfma_f32_16x16x32_bf16 v[76:79], a[204:207], v[208:211], v[76:79]
    ds_read_b128 a[116:119], v240 offset:1280
    v_cvt_pk_bf16_f32 v212, v200, v201
    v_mfma_f32_16x16x32_bf16 v[80:83], a[208:211], v[208:211], v[80:83]
    buffer_load_dwordx4 v244, s[24:27], s14 offen offset:3072 nt lds
    v_mfma_f32_16x16x32_bf16 v[84:87], a[212:215], v[208:211], v[84:87]
    ds_read_b128 a[120:123], v240 offset:1536
    v_cvt_pk_bf16_f32 v213, v202, v203
    v_mfma_f32_16x16x32_bf16 v[88:91], a[216:219], v[208:211], v[88:91]
    v_exp_f32 v204, v204
    v_mfma_f32_16x16x32_bf16 v[92:95], a[220:223], v[208:211], v[92:95]
    s_waitcnt lgkmcnt(2)
    ds_read_b128 a[124:127], v240 offset:1792
    v_mfma_f32_16x16x32_bf16 v[192:195], a[96:99], a[0:3], 0
    v_exp_f32 v205, v205
    v_mfma_f32_16x16x32_bf16 v[192:195], a[100:103], a[4:7], v[192:195]
    ds_read_b64_tr_b16 a[170:171], v241 offset:1280
    v_cvt_pk_bf16_f32 v214, v204, v205
    v_mfma_f32_16x16x32_bf16 v[192:195], a[104:107], a[8:11], v[192:195]
    v_exp_f32 v206, v206
    v_mfma_f32_16x16x32_bf16 v[192:195], a[108:111], a[12:15], v[192:195]
    v_exp_f32 v207, v207
    v_mfma_f32_16x16x32_bf16 v[196:199], a[112:115], a[0:3], 0
    s_waitcnt lgkmcnt(3)
    ds_read_b64_tr_b16 a[172:173], v241 offset:264
    v_cvt_pk_bf16_f32 v215, v206, v207
    v_mfma_f32_16x16x32_bf16 v[196:199], a[116:119], a[4:7], v[196:199]
    s_waitcnt lgkmcnt(3)
    ds_read_b64_tr_b16 a[174:175], v241 offset:1288
    ds_read_b64_tr_b16 a[176:177], v241 offset:512
    v_mfma_f32_16x16x32_bf16 v[196:199], a[120:123], a[8:11], v[196:199]
    s_waitcnt lgkmcnt(4)
    v_fma_f32 v192, v192, s15, v216
    v_fma_f32 v193, v193, s15, v216
    v_mfma_f32_16x16x32_bf16 v[196:199], a[124:127], a[12:15], v[196:199]
    v_exp_f32 v192, v192
    v_smfmac_f32_16x16x64_bf16 a[232:235], a[252:255], v[208:215], v250
    v_exp_f32 v193, v193
    v_mfma_f32_16x16x32_bf16 v[160:163], a[192:195], v[212:215], v[160:163]
    v_fma_f32 v194, v194, s15, v216
    v_fma_f32 v195, v195, s15, v216
    v_mfma_f32_16x16x32_bf16 v[164:167], a[196:199], v[212:215], v[164:167]
    v_exp_f32 v194, v194
    v_mfma_f32_16x16x32_bf16 v[168:171], a[200:203], v[212:215], v[168:171]
    v_exp_f32 v195, v195
    v_mfma_f32_16x16x32_bf16 v[172:175], a[204:207], v[212:215], v[172:175]
    v_fma_f32 v196, v196, s15, v216
    v_cvt_pk_bf16_f32 v208, v192, v193
    v_mfma_f32_16x16x32_bf16 v[176:179], a[208:211], v[212:215], v[176:179]
    v_exp_f32 v196, v196
    v_mfma_f32_16x16x32_bf16 v[180:183], a[212:215], v[212:215], v[180:183]
    v_fma_f32 v197, v197, s15, v216
    v_fma_f32 v198, v198, s15, v216
    v_mfma_f32_16x16x32_bf16 v[184:187], a[216:219], v[212:215], v[184:187]
    v_exp_f32 v197, v197
    v_mfma_f32_16x16x32_bf16 v[188:191], a[220:223], v[212:215], v[188:191]
    v_cvt_pk_bf16_f32 v209, v194, v195
    v_fma_f32 v199, v199, s15, v216
    v_mfma_f32_16x16x32_bf16 v[200:203], a[96:99], a[16:19], v[220:223]
    ds_read_b64_tr_b16 a[178:179], v241 offset:1536
    v_cvt_pk_bf16_f32 v210, v196, v197
    v_mfma_f32_16x16x32_bf16 v[200:203], a[100:103], a[20:23], v[200:203]
    v_exp_f32 v198, v198
    v_mfma_f32_16x16x32_bf16 v[200:203], a[104:107], a[24:27], v[200:203]
    v_exp_f32 v199, v199
    v_mfma_f32_16x16x32_bf16 v[200:203], a[108:111], a[28:31], v[200:203]
    ds_read_b64_tr_b16 a[180:181], v241 offset:520
    v_cvt_pk_bf16_f32 v211, v198, v199
    v_mfma_f32_16x16x32_bf16 v[204:207], a[112:115], a[16:19], v[220:223]
    ds_read_b64_tr_b16 a[182:183], v241 offset:1544
    ds_read_b64_tr_b16 a[184:185], v241 offset:768
    v_mfma_f32_16x16x32_bf16 v[204:207], a[116:119], a[20:23], v[204:207]
    ds_read_b64_tr_b16 a[186:187], v241 offset:1792
    v_mfma_f32_16x16x32_bf16 v[204:207], a[120:123], a[24:27], v[204:207]
    ds_read_b64_tr_b16 a[188:189], v241 offset:776
    v_mfma_f32_16x16x32_bf16 v[204:207], a[124:127], a[28:31], v[204:207]
    ds_read_b64_tr_b16 a[190:191], v241 offset:1800
    v_mfma_f32_16x16x32_bf16 v[0:3], a[160:163], v[208:211], v[0:3]
    v_exp_f32 v200, v200
    v_mfma_f32_16x16x32_bf16 v[4:7], a[164:167], v[208:211], v[4:7]
    s_waitcnt lgkmcnt(6)
    v_exp_f32 v201, v201
    v_mfma_f32_16x16x32_bf16 v[8:11], a[168:171], v[208:211], v[8:11]
    v_exp_f32 v202, v202
    v_mfma_f32_16x16x32_bf16 v[12:15], a[172:175], v[208:211], v[12:15]
    v_exp_f32 v203, v203
    v_mfma_f32_16x16x32_bf16 v[16:19], a[176:179], v[208:211], v[16:19]
    s_waitcnt lgkmcnt(4)
    v_cvt_pk_bf16_f32 v212, v200, v201
    v_cvt_pk_bf16_f32 v213, v202, v203
    v_mfma_f32_16x16x32_bf16 v[20:23], a[180:183], v[208:211], v[20:23]
    s_waitcnt lgkmcnt(2)
    v_exp_f32 v204, v204
    v_mfma_f32_16x16x32_bf16 v[24:27], a[184:187], v[208:211], v[24:27]
    s_waitcnt lgkmcnt(0)
    v_exp_f32 v205, v205
    v_mfma_f32_16x16x32_bf16 v[28:31], a[188:191], v[208:211], v[28:31]
    s_add_u32 m0, s13, 20560
    s_mov_b32 s14, 81920
    v_cvt_pk_bf16_f32 v214, v204, v205
    v_mfma_f32_16x16x32_bf16 v[192:195], a[96:99], a[48:51], v[228:231]
    buffer_load_dwordx4 v244, s[20:23], s14 offen offset:0 nt lds
    v_mfma_f32_16x16x32_bf16 v[192:195], a[100:103], a[52:55], v[192:195]
    v_exp_f32 v206, v206
    v_mfma_f32_16x16x32_bf16 v[192:195], a[104:107], a[56:59], v[192:195]
    v_exp_f32 v207, v207
    v_mfma_f32_16x16x32_bf16 v[192:195], a[108:111], a[60:63], v[192:195]
    v_cvt_pk_bf16_f32 v215, v206, v207
    v_mfma_f32_16x16x32_bf16 v[196:199], a[112:115], a[48:51], v[228:231]
    buffer_load_dwordx4 v244, s[20:23], s14 offen offset:1024 nt lds
    v_mfma_f32_16x16x32_bf16 v[196:199], a[116:119], a[52:55], v[196:199]
    s_add_u32 m0, s92, 20560
    v_mfma_f32_16x16x32_bf16 v[196:199], a[120:123], a[56:59], v[196:199]
    v_exp_f32 v192, v192
    v_mfma_f32_16x16x32_bf16 v[196:199], a[124:127], a[60:63], v[196:199]
    v_exp_f32 v193, v193
    v_smfmac_f32_16x16x64_bf16 a[224:227], a[252:255], v[208:215], v250
    buffer_load_dwordx4 v244, s[24:27], s14 offen offset:2048 nt lds
    v_mfma_f32_16x16x32_bf16 v[32:35], a[160:163], v[212:215], v[32:35]
    v_exp_f32 v194, v194
    v_mfma_f32_16x16x32_bf16 v[36:39], a[164:167], v[212:215], v[36:39]
    v_exp_f32 v195, v195
    v_mfma_f32_16x16x32_bf16 v[40:43], a[168:171], v[212:215], v[40:43]
    v_cvt_pk_bf16_f32 v208, v192, v193
    v_cvt_pk_bf16_f32 v209, v194, v195
    v_mfma_f32_16x16x32_bf16 v[44:47], a[172:175], v[212:215], v[44:47]
    buffer_load_dwordx4 v244, s[24:27], s14 offen offset:3072 nt lds
    v_mfma_f32_16x16x32_bf16 v[48:51], a[176:179], v[212:215], v[48:51]
    v_exp_f32 v196, v196
    v_mfma_f32_16x16x32_bf16 v[52:55], a[180:183], v[212:215], v[52:55]
    v_exp_f32 v197, v197
    v_mfma_f32_16x16x32_bf16 v[56:59], a[184:187], v[212:215], v[56:59]
    v_cvt_pk_bf16_f32 v210, v196, v197
    v_mfma_f32_16x16x32_bf16 v[60:63], a[188:191], v[212:215], v[60:63]
    v_exp_f32 v198, v198
    v_mfma_f32_16x16x32_bf16 v[200:203], a[96:99], a[64:67], v[232:235]
    v_exp_f32 v199, v199
    v_mfma_f32_16x16x32_bf16 v[200:203], a[100:103], a[68:71], v[200:203]
    v_cvt_pk_bf16_f32 v211, v198, v199
    v_mfma_f32_16x16x32_bf16 v[200:203], a[104:107], a[72:75], v[200:203]
    v_mfma_f32_16x16x32_bf16 v[200:203], a[108:111], a[76:79], v[200:203]
    v_mfma_f32_16x16x32_bf16 v[204:207], a[112:115], a[64:67], v[232:235]
    v_mfma_f32_16x16x32_bf16 v[204:207], a[116:119], a[68:71], v[204:207]
    v_mfma_f32_16x16x32_bf16 v[204:207], a[120:123], a[72:75], v[204:207]
    v_exp_f32 v200, v200
    v_mfma_f32_16x16x32_bf16 v[204:207], a[124:127], a[76:79], v[204:207]
    v_exp_f32 v201, v201
    v_mfma_f32_16x16x32_bf16 v[96:99], a[160:163], v[208:211], v[96:99]
    v_exp_f32 v202, v202
    v_mfma_f32_16x16x32_bf16 v[100:103], a[164:167], v[208:211], v[100:103]
    v_exp_f32 v203, v203
    v_mfma_f32_16x16x32_bf16 v[104:107], a[168:171], v[208:211], v[104:107]
    v_cvt_pk_bf16_f32 v212, v200, v201
    v_cvt_pk_bf16_f32 v213, v202, v203
    v_mfma_f32_16x16x32_bf16 v[108:111], a[172:175], v[208:211], v[108:111]
    v_exp_f32 v204, v204
    v_mfma_f32_16x16x32_bf16 v[112:115], a[176:179], v[208:211], v[112:115]
    v_exp_f32 v205, v205
    v_mfma_f32_16x16x32_bf16 v[116:119], a[180:183], v[208:211], v[116:119]
    v_cvt_pk_bf16_f32 v214, v204, v205
    v_mfma_f32_16x16x32_bf16 v[120:123], a[184:187], v[208:211], v[120:123]
    v_exp_f32 v206, v206
    v_mfma_f32_16x16x32_bf16 v[124:127], a[188:191], v[208:211], v[124:127]
    s_waitcnt vmcnt(12)
    s_barrier
    v_mfma_f32_16x16x32_bf16 v[192:195], a[96:99], a[32:35], v[224:227]
    v_exp_f32 v207, v207
    v_mfma_f32_16x16x32_bf16 v[192:195], a[100:103], a[36:39], v[192:195]
    ds_read_b128 a[128:131], v240 offset:4112
    v_cvt_pk_bf16_f32 v215, v206, v207
    v_mfma_f32_16x16x32_bf16 v[192:195], a[104:107], a[40:43], v[192:195]
    ds_read_b64_tr_b16 a[192:193], v241 offset:4112
    v_mfma_f32_16x16x32_bf16 v[192:195], a[108:111], a[44:47], v[192:195]
    ds_read_b64_tr_b16 a[194:195], v241 offset:5136
    v_mfma_f32_16x16x32_bf16 v[196:199], a[112:115], a[32:35], v[224:227]
    ds_read_b64_tr_b16 a[196:197], v241 offset:4120
    v_mfma_f32_16x16x32_bf16 v[196:199], a[116:119], a[36:39], v[196:199]
    ds_read_b128 a[132:135], v240 offset:4368
    v_mfma_f32_16x16x32_bf16 v[196:199], a[120:123], a[40:43], v[196:199]
    v_exp_f32 v192, v192
    v_mfma_f32_16x16x32_bf16 v[196:199], a[124:127], a[44:47], v[196:199]
    v_exp_f32 v193, v193
    v_smfmac_f32_16x16x64_bf16 a[236:239], a[252:255], v[208:215], v250
    v_exp_f32 v194, v194
    v_mfma_f32_16x16x32_bf16 v[128:131], a[160:163], v[212:215], v[128:131]
    v_exp_f32 v195, v195
    v_mfma_f32_16x16x32_bf16 v[132:135], a[164:167], v[212:215], v[132:135]
    v_cvt_pk_bf16_f32 v208, v192, v193
    v_cvt_pk_bf16_f32 v209, v194, v195
    v_mfma_f32_16x16x32_bf16 v[136:139], a[168:171], v[212:215], v[136:139]
L_pad4:
    s_cbranch_execz L_warm
    v_exp_f32 v196, v196
    v_mfma_f32_16x16x32_bf16 v[140:143], a[172:175], v[212:215], v[140:143]
    v_exp_f32 v197, v197
    v_mfma_f32_16x16x32_bf16 v[144:147], a[176:179], v[212:215], v[144:147]
    ds_read_b128 a[136:139], v240 offset:4624
    v_cvt_pk_bf16_f32 v210, v196, v197
    v_mfma_f32_16x16x32_bf16 v[148:151], a[180:183], v[212:215], v[148:151]
    v_exp_f32 v198, v198
    v_mfma_f32_16x16x32_bf16 v[152:155], a[184:187], v[212:215], v[152:155]
    v_exp_f32 v199, v199
    v_mfma_f32_16x16x32_bf16 v[156:159], a[188:191], v[212:215], v[156:159]
    s_add_u32 m0, s13, 12336
    s_mov_b32 s14, 90112
    v_cvt_pk_bf16_f32 v211, v198, v199
    v_mfma_f32_16x16x32_bf16 v[200:203], a[96:99], a[80:83], v[236:239]
    buffer_load_dwordx4 v244, s[20:23], s14 offen offset:0 nt lds
    v_mfma_f32_16x16x32_bf16 v[200:203], a[100:103], a[84:87], v[200:203]
    ds_read_b128 a[140:143], v240 offset:4880
    v_mfma_f32_16x16x32_bf16 v[200:203], a[104:107], a[88:91], v[200:203]
    ds_read_b64_tr_b16 a[198:199], v241 offset:5144
    v_mfma_f32_16x16x32_bf16 v[200:203], a[108:111], a[92:95], v[200:203]
    ds_read_b64_tr_b16 a[200:201], v241 offset:4368
    v_mfma_f32_16x16x32_bf16 v[204:207], a[112:115], a[80:83], v[236:239]
    buffer_load_dwordx4 v244, s[20:23], s14 offen offset:1024 nt lds
    v_mfma_f32_16x16x32_bf16 v[204:207], a[116:119], a[84:87], v[204:207]
    s_add_u32 m0, s92, 12336
    ds_read_b128 a[144:147], v240 offset:5136
    v_mfma_f32_16x16x32_bf16 v[204:207], a[120:123], a[88:91], v[204:207]
    v_exp_f32 v200, v200
    v_mfma_f32_16x16x32_bf16 v[204:207], a[124:127], a[92:95], v[204:207]
    v_exp_f32 v201, v201
    v_mfma_f32_16x16x32_bf16 v[64:67], a[160:163], v[208:211], v[64:67]
    buffer_load_dwordx4 v244, s[24:27], s14 offen offset:2048 nt lds
    v_mfma_f32_16x16x32_bf16 v[68:71], a[164:167], v[208:211], v[68:71]
    v_exp_f32 v202, v202
    v_mfma_f32_16x16x32_bf16 v[72:75], a[168:171], v[208:211], v[72:75]
    v_exp_f32 v203, v203
    v_mfma_f32_16x16x32_bf16 v[76:79], a[172:175], v[208:211], v[76:79]
    ds_read_b128 a[148:151], v240 offset:5392
    v_cvt_pk_bf16_f32 v212, v200, v201
    v_mfma_f32_16x16x32_bf16 v[80:83], a[176:179], v[208:211], v[80:83]
    buffer_load_dwordx4 v244, s[24:27], s14 offen offset:3072 nt lds
    v_mfma_f32_16x16x32_bf16 v[84:87], a[180:183], v[208:211], v[84:87]
    ds_read_b128 a[152:155], v240 offset:5648
    v_cvt_pk_bf16_f32 v213, v202, v203
    v_mfma_f32_16x16x32_bf16 v[88:91], a[184:187], v[208:211], v[88:91]
    v_exp_f32 v204, v204
    v_mfma_f32_16x16x32_bf16 v[92:95], a[188:191], v[208:211], v[92:95]
    s_waitcnt vmcnt(12)
    s_barrier
    s_waitcnt lgkmcnt(2)
    v_mfma_f32_16x16x32_bf16 v[192:195], a[128:131], a[0:3], 0
    ds_read_b128 a[156:159], v240 offset:5904
    v_mfma_f32_16x16x32_bf16 v[192:195], a[132:135], a[4:7], v[192:195]
    v_exp_f32 v205, v205
    v_mfma_f32_16x16x32_bf16 v[192:195], a[136:139], a[8:11], v[192:195]
    ds_read_b64_tr_b16 a[202:203], v241 offset:5392
    v_cvt_pk_bf16_f32 v214, v204, v205
    v_mfma_f32_16x16x32_bf16 v[192:195], a[140:143], a[12:15], v[192:195]
    v_exp_f32 v206, v206
    v_mfma_f32_16x16x32_bf16 v[196:199], a[144:147], a[0:3], 0
    s_waitcnt lgkmcnt(3)
    v_exp_f32 v207, v207
    v_mfma_f32_16x16x32_bf16 v[196:199], a[148:151], a[4:7], v[196:199]
    s_waitcnt lgkmcnt(2)
    ds_read_b64_tr_b16 a[204:205], v241 offset:4376
    v_cvt_pk_bf16_f32 v215, v206, v207
    v_mfma_f32_16x16x32_bf16 v[196:199], a[152:155], a[8:11], v[196:199]
    s_waitcnt lgkmcnt(2)
    v_fma_f32 v192, v192, s15, v216
    v_fma_f32 v193, v193, s15, v216
    v_mfma_f32_16x16x32_bf16 v[196:199], a[156:159], a[12:15], v[196:199]
    v_exp_f32 v192, v192
    v_smfmac_f32_16x16x64_bf16 a[232:235], a[252:255], v[208:215], v250
    v_exp_f32 v193, v193
    v_mfma_f32_16x16x32_bf16 v[160:163], a[160:163], v[212:215], v[160:163]
    v_fma_f32 v194, v194, s15, v216
    v_fma_f32 v195, v195, s15, v216
    v_mfma_f32_16x16x32_bf16 v[164:167], a[164:167], v[212:215], v[164:167]
    v_exp_f32 v194, v194
    v_mfma_f32_16x16x32_bf16 v[168:171], a[168:171], v[212:215], v[168:171]
    v_exp_f32 v195, v195
    v_mfma_f32_16x16x32_bf16 v[172:175], a[172:175], v[212:215], v[172:175]
    v_fma_f32 v196, v196, s15, v216
    v_cvt_pk_bf16_f32 v208, v192, v193
    v_mfma_f32_16x16x32_bf16 v[176:179], a[176:179], v[212:215], v[176:179]
    v_exp_f32 v196, v196
    v_mfma_f32_16x16x32_bf16 v[180:183], a[180:183], v[212:215], v[180:183]
    v_fma_f32 v197, v197, s15, v216
    v_fma_f32 v198, v198, s15, v216
    v_mfma_f32_16x16x32_bf16 v[184:187], a[184:187], v[212:215], v[184:187]
    v_exp_f32 v197, v197
    v_mfma_f32_16x16x32_bf16 v[188:191], a[188:191], v[212:215], v[188:191]
    v_cvt_pk_bf16_f32 v209, v194, v195
    v_fma_f32 v199, v199, s15, v216
    v_mfma_f32_16x16x32_bf16 v[200:203], a[128:131], a[16:19], v[220:223]
    ds_read_b64_tr_b16 a[206:207], v241 offset:5400
    v_cvt_pk_bf16_f32 v210, v196, v197
    v_mfma_f32_16x16x32_bf16 v[200:203], a[132:135], a[20:23], v[200:203]
    v_exp_f32 v198, v198
    v_mfma_f32_16x16x32_bf16 v[200:203], a[136:139], a[24:27], v[200:203]
    v_exp_f32 v199, v199
    v_mfma_f32_16x16x32_bf16 v[200:203], a[140:143], a[28:31], v[200:203]
    ds_read_b64_tr_b16 a[208:209], v241 offset:4624
    ds_read_b64_tr_b16 a[210:211], v241 offset:5648
    v_mfma_f32_16x16x32_bf16 v[204:207], a[144:147], a[16:19], v[220:223]
    ds_read_b64_tr_b16 a[212:213], v241 offset:4632
    v_cvt_pk_bf16_f32 v211, v198, v199
    v_mfma_f32_16x16x32_bf16 v[204:207], a[148:151], a[20:23], v[204:207]
    ds_read_b64_tr_b16 a[214:215], v241 offset:5656
    ds_read_b64_tr_b16 a[216:217], v241 offset:4880
    v_mfma_f32_16x16x32_bf16 v[204:207], a[152:155], a[24:27], v[204:207]
    ds_read_b64_tr_b16 a[218:219], v241 offset:5904
    v_mfma_f32_16x16x32_bf16 v[204:207], a[156:159], a[28:31], v[204:207]
    ds_read_b64_tr_b16 a[220:221], v241 offset:4888
    ds_read_b64_tr_b16 a[222:223], v241 offset:5912
    v_mfma_f32_16x16x32_bf16 v[0:3], a[192:195], v[208:211], v[0:3]
    v_exp_f32 v200, v200
    v_mfma_f32_16x16x32_bf16 v[4:7], a[196:199], v[208:211], v[4:7]
    s_waitcnt lgkmcnt(8)
    v_exp_f32 v201, v201
    v_mfma_f32_16x16x32_bf16 v[8:11], a[200:203], v[208:211], v[8:11]
    v_exp_f32 v202, v202
    v_mfma_f32_16x16x32_bf16 v[12:15], a[204:207], v[208:211], v[12:15]
    s_waitcnt lgkmcnt(6)
    v_exp_f32 v203, v203
    v_mfma_f32_16x16x32_bf16 v[16:19], a[208:211], v[208:211], v[16:19]
    s_waitcnt lgkmcnt(4)
    v_cvt_pk_bf16_f32 v212, v200, v201
    v_cvt_pk_bf16_f32 v213, v202, v203
    v_mfma_f32_16x16x32_bf16 v[20:23], a[212:215], v[208:211], v[20:23]
    s_waitcnt lgkmcnt(2)
    v_exp_f32 v204, v204
    v_mfma_f32_16x16x32_bf16 v[24:27], a[216:219], v[208:211], v[24:27]
    s_waitcnt lgkmcnt(0)
    v_exp_f32 v205, v205
    v_mfma_f32_16x16x32_bf16 v[28:31], a[220:223], v[208:211], v[28:31]
    ds_read_b128 a[96:99], v240 offset:16448
    v_cvt_pk_bf16_f32 v214, v204, v205
    v_mfma_f32_16x16x32_bf16 v[192:195], a[128:131], a[32:35], v[224:227]
    v_exp_f32 v206, v206
    v_mfma_f32_16x16x32_bf16 v[192:195], a[132:135], a[36:39], v[192:195]
    v_exp_f32 v207, v207
    v_mfma_f32_16x16x32_bf16 v[192:195], a[136:139], a[40:43], v[192:195]
    ds_read_b128 a[100:103], v240 offset:16704
    v_cvt_pk_bf16_f32 v215, v206, v207
    v_mfma_f32_16x16x32_bf16 v[192:195], a[140:143], a[44:47], v[192:195]
    buffer_load_dword v248, v255, s[28:31], 0 offen nt
    v_mfma_f32_16x16x32_bf16 v[196:199], a[144:147], a[32:35], v[224:227]
    ds_read_b128 a[104:107], v240 offset:16960
    v_mfma_f32_16x16x32_bf16 v[196:199], a[148:151], a[36:39], v[196:199]
    ds_read_b64_tr_b16 a[160:161], v241 offset:16448
    v_mfma_f32_16x16x32_bf16 v[196:199], a[152:155], a[40:43], v[196:199]
    v_exp_f32 v192, v192
    v_mfma_f32_16x16x32_bf16 v[196:199], a[156:159], a[44:47], v[196:199]
    v_exp_f32 v193, v193
    v_smfmac_f32_16x16x64_bf16 a[224:227], a[252:255], v[208:215], v250
    ds_read_b128 a[108:111], v240 offset:17216
    v_mfma_f32_16x16x32_bf16 v[32:35], a[192:195], v[212:215], v[32:35]
    v_exp_f32 v194, v194
    v_mfma_f32_16x16x32_bf16 v[36:39], a[196:199], v[212:215], v[36:39]
    ds_read_b128 a[112:115], v240 offset:17472
    v_cvt_pk_bf16_f32 v208, v192, v193
    v_mfma_f32_16x16x32_bf16 v[40:43], a[200:203], v[212:215], v[40:43]
    v_exp_f32 v195, v195
    v_mfma_f32_16x16x32_bf16 v[44:47], a[204:207], v[212:215], v[44:47]
    ds_read_b128 a[116:119], v240 offset:17728
    v_cvt_pk_bf16_f32 v209, v194, v195
    v_mfma_f32_16x16x32_bf16 v[48:51], a[208:211], v[212:215], v[48:51]
    v_exp_f32 v196, v196
    v_mfma_f32_16x16x32_bf16 v[52:55], a[212:215], v[212:215], v[52:55]
    ds_read_b128 a[120:123], v240 offset:17984
    v_mfma_f32_16x16x32_bf16 v[56:59], a[216:219], v[212:215], v[56:59]
    v_exp_f32 v197, v197
    v_mfma_f32_16x16x32_bf16 v[60:63], a[220:223], v[212:215], v[60:63]
    s_waitcnt vmcnt(9)
    s_barrier
    s_waitcnt lgkmcnt(4)
    v_mfma_f32_16x16x32_bf16 v[200:203], a[96:99], a[32:35], v[224:227]
    ds_read_b128 a[124:127], v240 offset:18240
    v_cvt_pk_bf16_f32 v210, v196, v197
    v_mfma_f32_16x16x32_bf16 v[200:203], a[100:103], a[36:39], v[200:203]
    v_exp_f32 v198, v198
    v_mfma_f32_16x16x32_bf16 v[200:203], a[104:107], a[40:43], v[200:203]
    s_waitcnt lgkmcnt(3)
    v_exp_f32 v199, v199
    v_mfma_f32_16x16x32_bf16 v[200:203], a[108:111], a[44:47], v[200:203]
    ds_read_b64_tr_b16 a[162:163], v241 offset:17472
    v_cvt_pk_bf16_f32 v211, v198, v199
    v_mfma_f32_16x16x32_bf16 v[204:207], a[112:115], a[32:35], v[224:227]
    s_waitcnt lgkmcnt(3)
    ds_read_b64_tr_b16 a[164:165], v241 offset:16456
    ds_read_b64_tr_b16 a[166:167], v241 offset:17480
    v_mfma_f32_16x16x32_bf16 v[204:207], a[116:119], a[36:39], v[204:207]
    s_waitcnt lgkmcnt(4)
    ds_read_b64_tr_b16 a[168:169], v241 offset:16704
    v_mfma_f32_16x16x32_bf16 v[204:207], a[120:123], a[40:43], v[204:207]
    s_waitcnt lgkmcnt(4)
    v_exp_f32 v200, v200
    v_mfma_f32_16x16x32_bf16 v[204:207], a[124:127], a[44:47], v[204:207]
    v_exp_f32 v201, v201
    v_mfma_f32_16x16x32_bf16 v[64:67], a[192:195], v[208:211], v[64:67]
    v_exp_f32 v202, v202
    v_mfma_f32_16x16x32_bf16 v[68:71], a[196:199], v[208:211], v[68:71]
    v_exp_f32 v203, v203
    v_mfma_f32_16x16x32_bf16 v[72:75], a[200:203], v[208:211], v[72:75]
    v_cvt_pk_bf16_f32 v212, v200, v201
    v_cvt_pk_bf16_f32 v213, v202, v203
    v_mfma_f32_16x16x32_bf16 v[76:79], a[204:207], v[208:211], v[76:79]
    v_exp_f32 v204, v204
    v_mfma_f32_16x16x32_bf16 v[80:83], a[208:211], v[208:211], v[80:83]
    v_exp_f32 v205, v205
    v_mfma_f32_16x16x32_bf16 v[84:87], a[212:215], v[208:211], v[84:87]
    ds_read_b64_tr_b16 a[170:171], v241 offset:17728
    v_cvt_pk_bf16_f32 v214, v204, v205
    v_mfma_f32_16x16x32_bf16 v[88:91], a[216:219], v[208:211], v[88:91]
    v_exp_f32 v206, v206
    v_mfma_f32_16x16x32_bf16 v[92:95], a[220:223], v[208:211], v[92:95]
    v_exp_f32 v207, v207
    v_mfma_f32_16x16x32_bf16 v[192:195], a[96:99], a[0:3], 0
    ds_read_b64_tr_b16 a[172:173], v241 offset:16712
    ds_read_b64_tr_b16 a[174:175], v241 offset:17736
    v_mfma_f32_16x16x32_bf16 v[192:195], a[100:103], a[4:7], v[192:195]
    ds_read_b64_tr_b16 a[176:177], v241 offset:16960
    v_cvt_pk_bf16_f32 v215, v206, v207
    v_mfma_f32_16x16x32_bf16 v[192:195], a[104:107], a[8:11], v[192:195]
    ds_read_b64_tr_b16 a[178:179], v241 offset:17984
    ds_read_b64_tr_b16 a[180:181], v241 offset:16968
    v_mfma_f32_16x16x32_bf16 v[192:195], a[108:111], a[12:15], v[192:195]
    ds_read_b64_tr_b16 a[182:183], v241 offset:17992
    v_mfma_f32_16x16x32_bf16 v[196:199], a[112:115], a[0:3], 0
    ds_read_b64_tr_b16 a[184:185], v241 offset:17216
    ds_read_b64_tr_b16 a[186:187], v241 offset:18240
    v_mfma_f32_16x16x32_bf16 v[196:199], a[116:119], a[4:7], v[196:199]
    ds_read_b64_tr_b16 a[188:189], v241 offset:17224
    v_mfma_f32_16x16x32_bf16 v[196:199], a[120:123], a[8:11], v[196:199]
    ds_read_b64_tr_b16 a[190:191], v241 offset:18248
    v_fma_f32 v192, v192, s15, v216
    v_mfma_f32_16x16x32_bf16 v[196:199], a[124:127], a[12:15], v[196:199]
    v_fma_f32 v193, v193, s15, v216
    v_fma_f32 v194, v194, s15, v216
    v_smfmac_f32_16x16x64_bf16 a[232:235], a[248:251], v[208:215], v250
    s_waitcnt lgkmcnt(8)
    v_exp_f32 v192, v192
    v_mfma_f32_16x16x32_bf16 v[64:67], a[160:163], v[212:215], v[64:67]
    v_exp_f32 v193, v193
    v_mfma_f32_16x16x32_bf16 v[68:71], a[164:167], v[212:215], v[68:71]
    v_fma_f32 v195, v195, s15, v216
    v_fma_f32 v196, v196, s15, v216
    v_mfma_f32_16x16x32_bf16 v[72:75], a[168:171], v[212:215], v[72:75]
    v_exp_f32 v194, v194
    v_mfma_f32_16x16x32_bf16 v[76:79], a[172:175], v[212:215], v[76:79]
    s_waitcnt lgkmcnt(3)
    v_exp_f32 v195, v195
    v_mfma_f32_16x16x32_bf16 v[80:83], a[176:179], v[212:215], v[80:83]
    v_cvt_pk_bf16_f32 v208, v192, v193
    v_fma_f32 v197, v197, s15, v216
    v_mfma_f32_16x16x32_bf16 v[84:87], a[180:183], v[212:215], v[84:87]
    s_waitcnt lgkmcnt(0)
    v_exp_f32 v196, v196
    v_mfma_f32_16x16x32_bf16 v[88:91], a[184:187], v[212:215], v[88:91]
    v_exp_f32 v197, v197
    v_mfma_f32_16x16x32_bf16 v[92:95], a[188:191], v[212:215], v[92:95]
    v_fma_f32 v198, v198, s15, v216
    v_cvt_pk_bf16_f32 v209, v194, v195
    v_mfma_f32_16x16x32_bf16 v[200:203], a[96:99], a[16:19], v[220:223]
    v_fma_f32 v199, v199, s15, v216
    v_cvt_pk_bf16_f32 v210, v196, v197
    v_mfma_f32_16x16x32_bf16 v[200:203], a[100:103], a[20:23], v[200:203]
    v_exp_f32 v198, v198
    v_mfma_f32_16x16x32_bf16 v[200:203], a[104:107], a[24:27], v[200:203]
    v_exp_f32 v199, v199
    v_mfma_f32_16x16x32_bf16 v[200:203], a[108:111], a[28:31], v[200:203]
    ds_read_b128 a[128:131], v240 offset:8224
    v_cvt_pk_bf16_f32 v211, v198, v199
    v_mfma_f32_16x16x32_bf16 v[204:207], a[112:115], a[16:19], v[220:223]
    ds_read_b64_tr_b16 a[192:193], v241 offset:8224
    v_mfma_f32_16x16x32_bf16 v[204:207], a[116:119], a[20:23], v[204:207]
    ds_read_b128 a[132:135], v240 offset:8480
    v_mfma_f32_16x16x32_bf16 v[204:207], a[120:123], a[24:27], v[204:207]
    v_exp_f32 v200, v200
    v_mfma_f32_16x16x32_bf16 v[204:207], a[124:127], a[28:31], v[204:207]
    v_exp_f32 v201, v201
    v_mfma_f32_16x16x32_bf16 v[0:3], a[160:163], v[208:211], v[0:3]
    ds_read_b128 a[136:139], v240 offset:8736
    v_cvt_pk_bf16_f32 v212, v200, v201
    v_mfma_f32_16x16x32_bf16 v[4:7], a[164:167], v[208:211], v[4:7]
    v_exp_f32 v202, v202
    v_mfma_f32_16x16x32_bf16 v[8:11], a[168:171], v[208:211], v[8:11]
    ds_read_b128 a[140:143], v240 offset:8992
    v_mfma_f32_16x16x32_bf16 v[12:15], a[172:175], v[208:211], v[12:15]
    v_exp_f32 v203, v203
    v_mfma_f32_16x16x32_bf16 v[16:19], a[176:179], v[208:211], v[16:19]
    ds_read_b128 a[144:147], v240 offset:9248
    v_cvt_pk_bf16_f32 v213, v202, v203
    v_mfma_f32_16x16x32_bf16 v[20:23], a[180:183], v[208:211], v[20:23]
    v_exp_f32 v204, v204
    v_mfma_f32_16x16x32_bf16 v[24:27], a[184:187], v[208:211], v[24:27]
    ds_read_b128 a[148:151], v240 offset:9504
    v_mfma_f32_16x16x32_bf16 v[28:31], a[188:191], v[208:211], v[28:31]
    s_waitcnt lgkmcnt(4)
    ds_read_b128 a[152:155], v240 offset:9760
    v_mfma_f32_16x16x32_bf16 v[192:195], a[128:131], a[0:3], 0
    ds_read_b128 a[156:159], v240 offset:10016
    v_mfma_f32_16x16x32_bf16 v[192:195], a[132:135], a[4:7], v[192:195]
    s_waitcnt lgkmcnt(5)
    v_exp_f32 v205, v205
    v_mfma_f32_16x16x32_bf16 v[192:195], a[136:139], a[8:11], v[192:195]
    s_waitcnt lgkmcnt(4)
    ds_read_b64_tr_b16 a[194:195], v241 offset:9248
    v_cvt_pk_bf16_f32 v214, v204, v205
    v_mfma_f32_16x16x32_bf16 v[192:195], a[140:143], a[12:15], v[192:195]
    s_waitcnt lgkmcnt(4)
    v_exp_f32 v206, v206
    v_mfma_f32_16x16x32_bf16 v[196:199], a[144:147], a[0:3], 0
    s_waitcnt lgkmcnt(3)
    v_exp_f32 v207, v207
    v_mfma_f32_16x16x32_bf16 v[196:199], a[148:151], a[4:7], v[196:199]
    s_waitcnt lgkmcnt(2)
    ds_read_b64_tr_b16 a[196:197], v241 offset:8232
    v_cvt_pk_bf16_f32 v215, v206, v207
    v_mfma_f32_16x16x32_bf16 v[196:199], a[152:155], a[8:11], v[196:199]
    s_waitcnt lgkmcnt(2)
    v_fma_f32 v192, v192, s15, v216
    v_fma_f32 v193, v193, s15, v216
    v_mfma_f32_16x16x32_bf16 v[196:199], a[156:159], a[12:15], v[196:199]
    v_exp_f32 v192, v192
    v_smfmac_f32_16x16x64_bf16 a[224:227], a[252:255], v[208:215], v250
    v_exp_f32 v193, v193
    v_mfma_f32_16x16x32_bf16 v[32:35], a[160:163], v[212:215], v[32:35]
    v_fma_f32 v194, v194, s15, v216
    v_fma_f32 v195, v195, s15, v216
    v_mfma_f32_16x16x32_bf16 v[36:39], a[164:167], v[212:215], v[36:39]
    v_exp_f32 v194, v194
    v_mfma_f32_16x16x32_bf16 v[40:43], a[168:171], v[212:215], v[40:43]
    v_exp_f32 v195, v195
    v_mfma_f32_16x16x32_bf16 v[44:47], a[172:175], v[212:215], v[44:47]
    v_fma_f32 v196, v196, s15, v216
    v_cvt_pk_bf16_f32 v208, v192, v193
    v_mfma_f32_16x16x32_bf16 v[48:51], a[176:179], v[212:215], v[48:51]
    v_exp_f32 v196, v196
    v_mfma_f32_16x16x32_bf16 v[52:55], a[180:183], v[212:215], v[52:55]
    v_fma_f32 v197, v197, s15, v216
    v_fma_f32 v198, v198, s15, v216
    v_mfma_f32_16x16x32_bf16 v[56:59], a[184:187], v[212:215], v[56:59]
    v_exp_f32 v197, v197
    v_mfma_f32_16x16x32_bf16 v[60:63], a[188:191], v[212:215], v[60:63]
    s_waitcnt vmcnt(7)
    s_barrier
    v_mfma_f32_16x16x32_bf16 v[200:203], a[128:131], a[16:19], v[220:223]
    ds_read_b64_tr_b16 a[198:199], v241 offset:9256
    v_cvt_pk_bf16_f32 v209, v194, v195
    v_mfma_f32_16x16x32_bf16 v[200:203], a[132:135], a[20:23], v[200:203]
    v_fma_f32 v199, v199, s15, v216
    v_cvt_pk_bf16_f32 v210, v196, v197
    v_mfma_f32_16x16x32_bf16 v[200:203], a[136:139], a[24:27], v[200:203]
    ds_read_b64_tr_b16 a[200:201], v241 offset:8480
    ds_read_b64_tr_b16 a[202:203], v241 offset:9504
    v_mfma_f32_16x16x32_bf16 v[200:203], a[140:143], a[28:31], v[200:203]
    v_exp_f32 v198, v198
    v_mfma_f32_16x16x32_bf16 v[204:207], a[144:147], a[16:19], v[220:223]
    ds_read_b64_tr_b16 a[204:205], v241 offset:8488
    ds_read_b64_tr_b16 a[206:207], v241 offset:9512
    v_mfma_f32_16x16x32_bf16 v[204:207], a[148:151], a[20:23], v[204:207]
    ds_read_b64_tr_b16 a[208:209], v241 offset:8736
    ds_read_b64_tr_b16 a[210:211], v241 offset:9760
    v_exp_f32 v199, v199
    v_mfma_f32_16x16x32_bf16 v[204:207], a[152:155], a[24:27], v[204:207]
    ds_read_b64_tr_b16 a[212:213], v241 offset:8744
    ds_read_b64_tr_b16 a[214:215], v241 offset:9768
    v_cvt_pk_bf16_f32 v211, v198, v199
    v_mfma_f32_16x16x32_bf16 v[204:207], a[156:159], a[28:31], v[204:207]
    s_waitcnt lgkmcnt(8)
    ds_read_b64_tr_b16 a[216:217], v241 offset:8992
    ds_read_b64_tr_b16 a[218:219], v241 offset:10016
    v_mfma_f32_16x16x32_bf16 v[0:3], a[192:195], v[208:211], v[0:3]
    ds_read_b64_tr_b16 a[220:221], v241 offset:9000
    ds_read_b64_tr_b16 a[222:223], v241 offset:10024
    v_mfma_f32_16x16x32_bf16 v[4:7], a[196:199], v[208:211], v[4:7]
    s_waitcnt lgkmcnt(10)
    ds_read_b128 a[96:99], v240 offset:20560
    v_mfma_f32_16x16x32_bf16 v[8:11], a[200:203], v[208:211], v[8:11]
    s_waitcnt lgkmcnt(9)
    ds_read_b128 a[100:103], v240 offset:20816
    v_exp_f32 v200, v200
    v_mfma_f32_16x16x32_bf16 v[12:15], a[204:207], v[208:211], v[12:15]
    s_waitcnt lgkmcnt(8)
    ds_read_b128 a[104:107], v240 offset:21072
    v_exp_f32 v201, v201
    v_mfma_f32_16x16x32_bf16 v[16:19], a[208:211], v[208:211], v[16:19]
    s_waitcnt lgkmcnt(7)
    ds_read_b128 a[108:111], v240 offset:21328
    v_cvt_pk_bf16_f32 v212, v200, v201
    v_mfma_f32_16x16x32_bf16 v[20:23], a[212:215], v[208:211], v[20:23]
    s_waitcnt lgkmcnt(6)
    ds_read_b128 a[112:115], v240 offset:21584
    v_exp_f32 v202, v202
    v_mfma_f32_16x16x32_bf16 v[24:27], a[216:219], v[208:211], v[24:27]
    s_waitcnt lgkmcnt(5)
    ds_read_b128 a[116:119], v240 offset:21840
    v_exp_f32 v203, v203
    v_mfma_f32_16x16x32_bf16 v[28:31], a[220:223], v[208:211], v[28:31]
    s_waitcnt vmcnt(3) lgkmcnt(4)
    ds_read_b128 a[120:123], v240 offset:22096
    v_cvt_pk_bf16_f32 v213, v202, v203
    v_mfma_f32_16x16x32_bf16 v[192:195], a[96:99], a[0:3], 0
    ds_read_b128 a[124:127], v240 offset:22352
    s_barrier
    v_exp_f32 v204, v204
    v_mfma_f32_16x16x32_bf16 v[192:195], a[100:103], a[4:7], v[192:195]
    s_waitcnt lgkmcnt(5)
    v_exp_f32 v205, v205
    v_mfma_f32_16x16x32_bf16 v[192:195], a[104:107], a[8:11], v[192:195]
    s_waitcnt lgkmcnt(4)
    ds_read_b64_tr_b16 a[160:161], v241 offset:20560
    v_cvt_pk_bf16_f32 v214, v204, v205
    v_mfma_f32_16x16x32_bf16 v[192:195], a[108:111], a[12:15], v[192:195]
    s_waitcnt lgkmcnt(4)
    v_exp_f32 v206, v206
    v_mfma_f32_16x16x32_bf16 v[196:199], a[112:115], a[0:3], 0
    s_waitcnt lgkmcnt(3)
    v_exp_f32 v207, v207
    v_mfma_f32_16x16x32_bf16 v[196:199], a[116:119], a[4:7], v[196:199]
    s_waitcnt lgkmcnt(2)
    ds_read_b128 a[128:131], v240 offset:12336
    v_cvt_pk_bf16_f32 v215, v206, v207
    v_mfma_f32_16x16x32_bf16 v[196:199], a[120:123], a[8:11], v[196:199]
    s_waitcnt lgkmcnt(2)
    v_fma_f32 v192, v192, s15, v216
    v_fma_f32 v193, v193, s15, v216
    v_mfma_f32_16x16x32_bf16 v[196:199], a[124:127], a[12:15], v[196:199]
    v_exp_f32 v192, v192
    v_smfmac_f32_16x16x64_bf16 a[224:227], a[252:255], v[208:215], v250
    ds_read_b128 a[132:135], v240 offset:12592
    v_fma_f32 v194, v194, s15, v216
    v_mfma_f32_16x16x32_bf16 v[32:35], a[192:195], v[212:215], v[32:35]
    v_exp_f32 v193, v193
    v_mfma_f32_16x16x32_bf16 v[36:39], a[196:199], v[212:215], v[36:39]
    ds_read_b128 a[136:139], v240 offset:12848
    v_fma_f32 v195, v195, s15, v216
    v_mfma_f32_16x16x32_bf16 v[40:43], a[200:203], v[212:215], v[40:43]
    v_exp_f32 v194, v194
    v_mfma_f32_16x16x32_bf16 v[44:47], a[204:207], v[212:215], v[44:47]
    ds_read_b128 a[140:143], v240 offset:13104
    v_fma_f32 v196, v196, s15, v216
    v_mfma_f32_16x16x32_bf16 v[48:51], a[208:211], v[212:215], v[48:51]
    v_exp_f32 v195, v195
    v_mfma_f32_16x16x32_bf16 v[52:55], a[212:215], v[212:215], v[52:55]
    ds_read_b128 a[144:147], v240 offset:13360
    v_cvt_pk_bf16_f32 v208, v192, v193
    v_mfma_f32_16x16x32_bf16 v[56:59], a[216:219], v[212:215], v[56:59]
    ds_read_b128 a[148:151], v240 offset:13616
    v_fma_f32 v197, v197, s15, v216
    v_mfma_f32_16x16x32_bf16 v[60:63], a[220:223], v[212:215], v[60:63]
    s_waitcnt vmcnt(1) lgkmcnt(4)
    ds_read_b128 a[152:155], v240 offset:13872
    v_fma_f32 v198, v198, s15, v216
    v_mfma_f32_16x16x32_bf16 v[200:203], a[128:131], a[0:3], 0
    ds_read_b128 a[156:159], v240 offset:14128
    s_barrier
    v_exp_f32 v196, v196
    v_mfma_f32_16x16x32_bf16 v[200:203], a[132:135], a[4:7], v[200:203]
    s_waitcnt lgkmcnt(5)
    ds_read_b64_tr_b16 a[162:163], v241 offset:21584
    v_exp_f32 v197, v197
    v_mfma_f32_16x16x32_bf16 v[200:203], a[136:139], a[8:11], v[200:203]
    s_waitcnt lgkmcnt(5)
    ds_read_b64_tr_b16 a[164:165], v241 offset:20568
    ds_read_b64_tr_b16 a[166:167], v241 offset:21592
    v_cvt_pk_bf16_f32 v209, v194, v195
    v_mfma_f32_16x16x32_bf16 v[200:203], a[140:143], a[12:15], v[200:203]
    s_waitcnt lgkmcnt(5)
    ds_read_b64_tr_b16 a[168:169], v241 offset:20816
    ds_read_b64_tr_b16 a[170:171], v241 offset:21840
    v_fma_f32 v199, v199, s15, v216
    v_cvt_pk_bf16_f32 v210, v196, v197
    v_mfma_f32_16x16x32_bf16 v[204:207], a[144:147], a[0:3], 0
    ds_read_b64_tr_b16 a[172:173], v241 offset:20824
    ds_read_b64_tr_b16 a[174:175], v241 offset:21848
    v_exp_f32 v198, v198
    v_mfma_f32_16x16x32_bf16 v[204:207], a[148:151], a[4:7], v[204:207]
    s_waitcnt lgkmcnt(6)
    ds_read_b64_tr_b16 a[176:177], v241 offset:21072
    ds_read_b64_tr_b16 a[178:179], v241 offset:22096
    v_exp_f32 v199, v199
    v_mfma_f32_16x16x32_bf16 v[204:207], a[152:155], a[8:11], v[204:207]
    ds_read_b64_tr_b16 a[180:181], v241 offset:21080
    ds_read_b64_tr_b16 a[182:183], v241 offset:22104
    v_cvt_pk_bf16_f32 v211, v198, v199
    v_mfma_f32_16x16x32_bf16 v[204:207], a[156:159], a[12:15], v[204:207]
    ds_read_b64_tr_b16 a[184:185], v241 offset:21328
    ds_read_b64_tr_b16 a[186:187], v241 offset:22352
    v_mfma_f32_16x16x32_bf16 v[0:3], a[160:163], v[208:211], v[0:3]
    s_waitcnt lgkmcnt(8)
    ds_read_b64_tr_b16 a[188:189], v241 offset:21336
    ds_read_b64_tr_b16 a[190:191], v241 offset:22360
    v_mfma_f32_16x16x32_bf16 v[4:7], a[164:167], v[208:211], v[4:7]
    v_fma_f32 v200, v200, s15, v216
    v_fma_f32 v201, v201, s15, v216
    v_mfma_f32_16x16x32_bf16 v[8:11], a[168:171], v[208:211], v[8:11]
    s_waitcnt lgkmcnt(8)
    v_exp_f32 v200, v200
    v_mfma_f32_16x16x32_bf16 v[12:15], a[172:175], v[208:211], v[12:15]
    s_waitcnt lgkmcnt(6)
    v_exp_f32 v201, v201
    v_mfma_f32_16x16x32_bf16 v[16:19], a[176:179], v[208:211], v[16:19]
    s_waitcnt lgkmcnt(4)
    v_fma_f32 v202, v202, s15, v216
    v_fma_f32 v203, v203, s15, v216
    v_mfma_f32_16x16x32_bf16 v[20:23], a[180:183], v[208:211], v[20:23]
    s_waitcnt lgkmcnt(2)
    v_exp_f32 v202, v202
    v_mfma_f32_16x16x32_bf16 v[24:27], a[184:187], v[208:211], v[24:27]
    s_waitcnt lgkmcnt(0)
    v_exp_f32 v203, v203
    v_mfma_f32_16x16x32_bf16 v[28:31], a[188:191], v[208:211], v[28:31]
    v_fma_f32 v204, v204, s15, v216
    v_cvt_pk_bf16_f32 v212, v200, v201
    v_mfma_f32_16x16x32_bf16 v[192:195], a[96:99], a[16:19], v[220:223]
    v_exp_f32 v204, v204
    v_fma_f32 v205, v205, s15, v216
    v_mfma_f32_16x16x32_bf16 v[192:195], a[100:103], a[20:23], v[192:195]
    v_exp_f32 v205, v205
    v_mfma_f32_16x16x32_bf16 v[192:195], a[104:107], a[24:27], v[192:195]
    ds_read_b64_tr_b16 a[192:193], v241 offset:12336
    ds_read_b64_tr_b16 a[194:195], v241 offset:13360
    v_fma_f32 v206, v206, s15, v216
    v_cvt_pk_bf16_f32 v213, v202, v203
    v_mfma_f32_16x16x32_bf16 v[192:195], a[108:111], a[28:31], v[192:195]
    ds_read_b64_tr_b16 a[196:197], v241 offset:12344
    ds_read_b64_tr_b16 a[198:199], v241 offset:13368
    v_fma_f32 v207, v207, s15, v216
    v_cvt_pk_bf16_f32 v214, v204, v205
    v_mfma_f32_16x16x32_bf16 v[196:199], a[112:115], a[16:19], v[220:223]
    ds_read_b64_tr_b16 a[200:201], v241 offset:12592
    ds_read_b64_tr_b16 a[202:203], v241 offset:13616
    v_exp_f32 v206, v206
    v_mfma_f32_16x16x32_bf16 v[196:199], a[116:119], a[20:23], v[196:199]
    ds_read_b64_tr_b16 a[204:205], v241 offset:12600
    ds_read_b64_tr_b16 a[206:207], v241 offset:13624
    v_exp_f32 v207, v207
    v_mfma_f32_16x16x32_bf16 v[196:199], a[120:123], a[24:27], v[196:199]
    ds_read_b64_tr_b16 a[208:209], v241 offset:12848
    ds_read_b64_tr_b16 a[210:211], v241 offset:13872
    v_cvt_pk_bf16_f32 v215, v206, v207
    v_mfma_f32_16x16x32_bf16 v[196:199], a[124:127], a[28:31], v[196:199]
    ds_read_b64_tr_b16 a[212:213], v241 offset:12856
    ds_read_b64_tr_b16 a[214:215], v241 offset:13880
    v_smfmac_f32_16x16x64_bf16 a[224:227], a[248:251], v[208:215], v250
    s_waitcnt lgkmcnt(9)
    ds_read_b64_tr_b16 a[216:217], v241 offset:13104
    ds_read_b64_tr_b16 a[218:219], v241 offset:14128
    v_mfma_f32_16x16x32_bf16 v[0:3], a[192:195], v[212:215], v[0:3]
    s_waitcnt lgkmcnt(10)
    ds_read_b64_tr_b16 a[220:221], v241 offset:13112
    ds_read_b64_tr_b16 a[222:223], v241 offset:14136
    v_mfma_f32_16x16x32_bf16 v[4:7], a[196:199], v[212:215], v[4:7]
    s_waitcnt lgkmcnt(10)
    v_exp_f32 v192, v192
    v_mfma_f32_16x16x32_bf16 v[8:11], a[200:203], v[212:215], v[8:11]
    s_waitcnt lgkmcnt(8)
    v_exp_f32 v193, v193
    v_mfma_f32_16x16x32_bf16 v[12:15], a[204:207], v[212:215], v[12:15]
    s_waitcnt lgkmcnt(6)
    v_exp_f32 v194, v194
    v_mfma_f32_16x16x32_bf16 v[16:19], a[208:211], v[212:215], v[16:19]
    s_waitcnt lgkmcnt(4)
    v_exp_f32 v195, v195
    v_mfma_f32_16x16x32_bf16 v[20:23], a[212:215], v[212:215], v[20:23]
    s_waitcnt lgkmcnt(2)
    v_cvt_pk_bf16_f32 v208, v192, v193
    v_cvt_pk_bf16_f32 v209, v194, v195
    v_mfma_f32_16x16x32_bf16 v[24:27], a[216:219], v[212:215], v[24:27]
    s_waitcnt lgkmcnt(0)
    v_exp_f32 v196, v196
    v_mfma_f32_16x16x32_bf16 v[28:31], a[220:223], v[212:215], v[28:31]
    v_exp_f32 v197, v197
    v_mfma_f32_16x16x32_bf16 v[200:203], a[128:131], a[16:19], v[220:223]
    v_accvgpr_read_b32 v218, a224
    v_accvgpr_read_b32 v219, a225
    v_mfma_f32_16x16x32_bf16 v[200:203], a[132:135], a[20:23], v[200:203]
    v_cvt_pk_bf16_f32 v210, v196, v197
    v_add_f32 v218, v218, v219
    v_mfma_f32_16x16x32_bf16 v[200:203], a[136:139], a[24:27], v[200:203]
    v_exp_f32 v198, v198
    v_mfma_f32_16x16x32_bf16 v[200:203], a[140:143], a[28:31], v[200:203]
    v_subrev_u32 v216, 0xd800000, v218
    v_cmp_lt_u32_e64 s[36:37], s34, v216
    v_mfma_f32_16x16x32_bf16 v[204:207], a[144:147], a[16:19], v[220:223]
    v_exp_f32 v199, v199
    v_mfma_f32_16x16x32_bf16 v[204:207], a[148:151], a[20:23], v[204:207]
    v_rcp_f32 v218, v218
    v_mfma_f32_16x16x32_bf16 v[204:207], a[152:155], a[24:27], v[204:207]
    v_cvt_pk_bf16_f32 v211, v198, v199
    v_mov_b32 v219, v218
    v_mfma_f32_16x16x32_bf16 v[204:207], a[156:159], a[28:31], v[204:207]
L_pad5:
    s_cbranch_execz L_warm
    v_exp_f32 v200, v200
    v_mfma_f32_16x16x32_bf16 v[32:35], a[160:163], v[208:211], v[32:35]
    v_pk_mul_f32 v[0:1], v[0:1], v[218:219]
    v_pk_mul_f32 v[2:3], v[2:3], v[218:219]
    v_pk_mul_f32 v[4:5], v[4:5], v[218:219]
    v_pk_mul_f32 v[6:7], v[6:7], v[218:219]
    v_pk_mul_f32 v[8:9], v[8:9], v[218:219]
    v_pk_mul_f32 v[10:11], v[10:11], v[218:219]
    v_pk_mul_f32 v[12:13], v[12:13], v[218:219]
    v_pk_mul_f32 v[14:15], v[14:15], v[218:219]
    v_pk_mul_f32 v[16:17], v[16:17], v[218:219]
    v_pk_mul_f32 v[18:19], v[18:19], v[218:219]
    v_pk_mul_f32 v[20:21], v[20:21], v[218:219]
    v_pk_mul_f32 v[22:23], v[22:23], v[218:219]
    v_pk_mul_f32 v[24:25], v[24:25], v[218:219]
    v_pk_mul_f32 v[26:27], v[26:27], v[218:219]
    v_pk_mul_f32 v[28:29], v[28:29], v[218:219]
    v_pk_mul_f32 v[30:31], v[30:31], v[218:219]
    v_mfma_f32_16x16x32_bf16 v[36:39], a[164:167], v[208:211], v[36:39]
    v_exp_f32 v201, v201
    v_mfma_f32_16x16x32_bf16 v[40:43], a[168:171], v[208:211], v[40:43]
    v_exp_f32 v202, v202
    v_mfma_f32_16x16x32_bf16 v[44:47], a[172:175], v[208:211], v[44:47]
    v_exp_f32 v203, v203
    v_mfma_f32_16x16x32_bf16 v[48:51], a[176:179], v[208:211], v[48:51]
    v_cvt_pk_bf16_f32 v212, v200, v201
    v_cvt_pk_bf16_f32 v0, v0, v1
    v_mfma_f32_16x16x32_bf16 v[52:55], a[180:183], v[208:211], v[52:55]
    v_cvt_pk_bf16_f32 v1, v2, v3
    v_cvt_pk_bf16_f32 v2, v4, v5
    v_mfma_f32_16x16x32_bf16 v[56:59], a[184:187], v[208:211], v[56:59]
    v_cvt_pk_bf16_f32 v3, v6, v7
    v_cvt_pk_bf16_f32 v8, v8, v9
    v_mfma_f32_16x16x32_bf16 v[60:63], a[188:191], v[208:211], v[60:63]
    v_exp_f32 v204, v204
    v_mfma_f32_16x16x32_bf16 v[192:195], a[96:99], a[32:35], v[224:227]
    v_cvt_pk_bf16_f32 v9, v10, v11
    v_cvt_pk_bf16_f32 v10, v12, v13
    v_mfma_f32_16x16x32_bf16 v[192:195], a[100:103], a[36:39], v[192:195]
    v_cvt_pk_bf16_f32 v11, v14, v15
    v_cndmask_b32_dpp v4, v0, v8, vcc row_ror:8 row_mask:0xf bank_mask:0xf
    v_cndmask_b32_dpp v5, v1, v9, vcc row_ror:8 row_mask:0xf bank_mask:0xf
    v_cndmask_b32_dpp v6, v2, v10, vcc row_ror:8 row_mask:0xf bank_mask:0xf
    v_cndmask_b32_dpp v7, v3, v11, vcc row_ror:8 row_mask:0xf bank_mask:0xf
    v_exp_f32 v205, v205
    v_mfma_f32_16x16x32_bf16 v[192:195], a[104:107], a[40:43], v[192:195]
    v_mov_b32_dpp v0, v8 row_ror:8 row_mask:0xf bank_mask:0xc
    v_mov_b32_dpp v1, v9 row_ror:8 row_mask:0xf bank_mask:0xc
    v_mov_b32_dpp v2, v10 row_ror:8 row_mask:0xf bank_mask:0xc
    v_mov_b32_dpp v3, v11 row_ror:8 row_mask:0xf bank_mask:0xc
    v_cvt_pk_bf16_f32 v213, v202, v203
    v_mfma_f32_16x16x32_bf16 v[192:195], a[108:111], a[44:47], v[192:195]
    buffer_store_dwordx4 v[0:3], v242, s[28:31], s48 offen offset:0 sc1 nt
    v_cvt_pk_bf16_f32 v214, v204, v205
    v_mfma_f32_16x16x32_bf16 v[196:199], a[112:115], a[32:35], v[224:227]
    v_exp_f32 v206, v206
    v_mfma_f32_16x16x32_bf16 v[196:199], a[116:119], a[36:39], v[196:199]
    v_exp_f32 v207, v207
    v_mfma_f32_16x16x32_bf16 v[196:199], a[120:123], a[40:43], v[196:199]
    v_cvt_pk_bf16_f32 v215, v206, v207
    v_cvt_pk_bf16_f32 v8, v16, v17
    v_mfma_f32_16x16x32_bf16 v[196:199], a[124:127], a[44:47], v[196:199]
    v_exp_f32 v192, v192
    v_smfmac_f32_16x16x64_bf16 a[228:231], a[248:251], v[208:215], v250
    v_exp_f32 v193, v193
    v_mfma_f32_16x16x32_bf16 v[32:35], a[192:195], v[212:215], v[32:35]
    v_exp_f32 v194, v194
    v_mfma_f32_16x16x32_bf16 v[36:39], a[196:199], v[212:215], v[36:39]
    v_exp_f32 v195, v195
    v_mfma_f32_16x16x32_bf16 v[40:43], a[200:203], v[212:215], v[40:43]
    v_cvt_pk_bf16_f32 v208, v192, v193
    v_cvt_pk_bf16_f32 v209, v194, v195
    v_mfma_f32_16x16x32_bf16 v[44:47], a[204:207], v[212:215], v[44:47]
    v_exp_f32 v196, v196
    v_mfma_f32_16x16x32_bf16 v[48:51], a[208:211], v[212:215], v[48:51]
    v_exp_f32 v197, v197
    v_mfma_f32_16x16x32_bf16 v[52:55], a[212:215], v[212:215], v[52:55]
    v_accvgpr_read_b32 v222, a228
    v_accvgpr_read_b32 v223, a229
    v_mfma_f32_16x16x32_bf16 v[56:59], a[216:219], v[212:215], v[56:59]
    v_accvgpr_read_b32 v220, a226
    v_accvgpr_read_b32 v221, a227
    v_mfma_f32_16x16x32_bf16 v[60:63], a[220:223], v[212:215], v[60:63]
    buffer_store_dwordx4 v[4:7], v242, s[28:31], s48 offen offset:2048 sc1 nt
    v_mfma_f32_16x16x32_bf16 v[200:203], a[128:131], a[32:35], v[224:227]
    v_cvt_pk_bf16_f32 v210, v196, v197
    v_add_f32 v222, v222, v223
    v_mfma_f32_16x16x32_bf16 v[200:203], a[132:135], a[36:39], v[200:203]
    v_add_f32 v222, v222, v220
    v_add_f32 v222, v222, v221
    v_mfma_f32_16x16x32_bf16 v[200:203], a[136:139], a[40:43], v[200:203]
    v_exp_f32 v198, v198
    v_mfma_f32_16x16x32_bf16 v[200:203], a[140:143], a[44:47], v[200:203]
    v_subrev_u32 v220, 0xd800000, v222
    v_cvt_pk_bf16_f32 v9, v18, v19
    v_mfma_f32_16x16x32_bf16 v[204:207], a[144:147], a[32:35], v[224:227]
    v_exp_f32 v199, v199
    v_mfma_f32_16x16x32_bf16 v[204:207], a[148:151], a[36:39], v[204:207]
    v_rcp_f32 v222, v222
    v_mfma_f32_16x16x32_bf16 v[204:207], a[152:155], a[40:43], v[204:207]
    v_cvt_pk_bf16_f32 v211, v198, v199
    v_mov_b32 v223, v222
    v_mfma_f32_16x16x32_bf16 v[204:207], a[156:159], a[44:47], v[204:207]
    v_exp_f32 v200, v200
    v_mfma_f32_16x16x32_bf16 v[64:67], a[160:163], v[208:211], v[64:67]
    v_pk_mul_f32 v[32:33], v[32:33], v[222:223]
    v_pk_mul_f32 v[34:35], v[34:35], v[222:223]
    v_pk_mul_f32 v[36:37], v[36:37], v[222:223]
    v_pk_mul_f32 v[38:39], v[38:39], v[222:223]
    v_pk_mul_f32 v[40:41], v[40:41], v[222:223]
    v_pk_mul_f32 v[42:43], v[42:43], v[222:223]
    v_pk_mul_f32 v[44:45], v[44:45], v[222:223]
    v_pk_mul_f32 v[46:47], v[46:47], v[222:223]
    v_pk_mul_f32 v[48:49], v[48:49], v[222:223]
    v_pk_mul_f32 v[50:51], v[50:51], v[222:223]
    v_pk_mul_f32 v[52:53], v[52:53], v[222:223]
    v_pk_mul_f32 v[54:55], v[54:55], v[222:223]
    v_pk_mul_f32 v[56:57], v[56:57], v[222:223]
    v_pk_mul_f32 v[58:59], v[58:59], v[222:223]
    v_pk_mul_f32 v[60:61], v[60:61], v[222:223]
    v_pk_mul_f32 v[62:63], v[62:63], v[222:223]
    v_mfma_f32_16x16x32_bf16 v[68:71], a[164:167], v[208:211], v[68:71]
    v_exp_f32 v201, v201
    v_mfma_f32_16x16x32_bf16 v[72:75], a[168:171], v[208:211], v[72:75]
    v_exp_f32 v202, v202
    v_mfma_f32_16x16x32_bf16 v[76:79], a[172:175], v[208:211], v[76:79]
    v_exp_f32 v203, v203
    v_mfma_f32_16x16x32_bf16 v[80:83], a[176:179], v[208:211], v[80:83]
    v_cvt_pk_bf16_f32 v10, v20, v21
    v_cvt_pk_bf16_f32 v11, v22, v23
    v_mfma_f32_16x16x32_bf16 v[84:87], a[180:183], v[208:211], v[84:87]
    v_cvt_pk_bf16_f32 v212, v200, v201
    v_cvt_pk_bf16_f32 v24, v24, v25
    v_mfma_f32_16x16x32_bf16 v[88:91], a[184:187], v[208:211], v[88:91]
    v_cvt_pk_bf16_f32 v25, v26, v27
    v_cvt_pk_bf16_f32 v26, v28, v29
    v_mfma_f32_16x16x32_bf16 v[92:95], a[188:191], v[208:211], v[92:95]
    v_cvt_pk_bf16_f32 v27, v30, v31
    v_cndmask_b32_dpp v12, v8, v24, vcc row_ror:8 row_mask:0xf bank_mask:0xf
    v_mfma_f32_16x16x32_bf16 v[192:195], a[96:99], a[48:51], v[228:231]
    v_cndmask_b32_dpp v13, v9, v25, vcc row_ror:8 row_mask:0xf bank_mask:0xf
    v_cndmask_b32_dpp v14, v10, v26, vcc row_ror:8 row_mask:0xf bank_mask:0xf
    v_cndmask_b32_dpp v15, v11, v27, vcc row_ror:8 row_mask:0xf bank_mask:0xf
    v_exp_f32 v204, v204
    v_mfma_f32_16x16x32_bf16 v[192:195], a[100:103], a[52:55], v[192:195]
    v_mov_b32_dpp v8, v24 row_ror:8 row_mask:0xf bank_mask:0xc
    v_mov_b32_dpp v9, v25 row_ror:8 row_mask:0xf bank_mask:0xc
    v_mov_b32_dpp v10, v26 row_ror:8 row_mask:0xf bank_mask:0xc
    v_mov_b32_dpp v11, v27 row_ror:8 row_mask:0xf bank_mask:0xc
    v_exp_f32 v205, v205
    v_mfma_f32_16x16x32_bf16 v[192:195], a[104:107], a[56:59], v[192:195]
    buffer_store_dwordx4 v[8:11], v242, s[28:31], s48 offen offset:128 sc1 nt
    v_cvt_pk_bf16_f32 v213, v202, v203
    v_mfma_f32_16x16x32_bf16 v[192:195], a[108:111], a[60:63], v[192:195]
    v_cmp_lt_u32_e64 s[38:39], s34, v220
    v_cvt_pk_bf16_f32 v214, v204, v205
    v_mfma_f32_16x16x32_bf16 v[196:199], a[112:115], a[48:51], v[228:231]
    v_exp_f32 v206, v206
    v_mfma_f32_16x16x32_bf16 v[196:199], a[116:119], a[52:55], v[196:199]
    v_exp_f32 v207, v207
    v_mfma_f32_16x16x32_bf16 v[196:199], a[120:123], a[56:59], v[196:199]
    ds_read_b128 a[0:3], v240 offset:8224
    v_cvt_pk_bf16_f32 v215, v206, v207
    v_mfma_f32_16x16x32_bf16 v[196:199], a[124:127], a[60:63], v[196:199]
    v_exp_f32 v192, v192
    v_smfmac_f32_16x16x64_bf16 a[232:235], a[248:251], v[208:215], v250
    v_exp_f32 v193, v193
    v_mfma_f32_16x16x32_bf16 v[64:67], a[192:195], v[212:215], v[64:67]
    v_exp_f32 v194, v194
    v_mfma_f32_16x16x32_bf16 v[68:71], a[196:199], v[212:215], v[68:71]
    v_exp_f32 v195, v195
    v_mfma_f32_16x16x32_bf16 v[72:75], a[200:203], v[212:215], v[72:75]
    v_cvt_pk_bf16_f32 v208, v192, v193
    v_cvt_pk_bf16_f32 v209, v194, v195
    v_mfma_f32_16x16x32_bf16 v[76:79], a[204:207], v[212:215], v[76:79]
    v_exp_f32 v196, v196
    v_mfma_f32_16x16x32_bf16 v[80:83], a[208:211], v[212:215], v[80:83]
    v_exp_f32 v197, v197
    v_mfma_f32_16x16x32_bf16 v[84:87], a[212:215], v[212:215], v[84:87]
    ds_read_b128 a[4:7], v240 offset:8480
    v_cvt_pk_bf16_f32 v210, v196, v197
    v_mfma_f32_16x16x32_bf16 v[88:91], a[216:219], v[212:215], v[88:91]
    buffer_store_dwordx4 v[12:15], v242, s[28:31], s48 offen offset:2176 sc1 nt
    v_mfma_f32_16x16x32_bf16 v[92:95], a[220:223], v[212:215], v[92:95]
    v_exp_f32 v198, v198
    v_mfma_f32_16x16x32_bf16 v[200:203], a[96:99], a[64:67], v[232:235]
    v_exp_f32 v199, v199
    v_mfma_f32_16x16x32_bf16 v[200:203], a[100:103], a[68:71], v[200:203]
    ds_read_b128 a[8:11], v240 offset:8736
    v_cvt_pk_bf16_f32 v211, v198, v199
    v_mfma_f32_16x16x32_bf16 v[200:203], a[104:107], a[72:75], v[200:203]
    v_cvt_pk_bf16_f32 v32, v32, v33
    v_cvt_pk_bf16_f32 v33, v34, v35
    v_mfma_f32_16x16x32_bf16 v[200:203], a[108:111], a[76:79], v[200:203]
    ds_read_b128 a[12:15], v240 offset:8992
    v_cvt_pk_bf16_f32 v34, v36, v37
    v_mfma_f32_16x16x32_bf16 v[204:207], a[112:115], a[64:67], v[232:235]
    v_cvt_pk_bf16_f32 v35, v38, v39
    v_cvt_pk_bf16_f32 v40, v40, v41
    v_mfma_f32_16x16x32_bf16 v[204:207], a[116:119], a[68:71], v[204:207]
    ds_read_b128 a[16:19], v240 offset:9248
    v_cvt_pk_bf16_f32 v41, v42, v43
    v_mfma_f32_16x16x32_bf16 v[204:207], a[120:123], a[72:75], v[204:207]
    v_exp_f32 v200, v200
    v_mfma_f32_16x16x32_bf16 v[204:207], a[124:127], a[76:79], v[204:207]
    v_exp_f32 v201, v201
    v_mfma_f32_16x16x32_bf16 v[96:99], a[160:163], v[208:211], v[96:99]
    v_exp_f32 v202, v202
    v_mfma_f32_16x16x32_bf16 v[100:103], a[164:167], v[208:211], v[100:103]
    v_exp_f32 v203, v203
    v_mfma_f32_16x16x32_bf16 v[104:107], a[168:171], v[208:211], v[104:107]
    ds_read_b128 a[20:23], v240 offset:9504
    v_cvt_pk_bf16_f32 v42, v44, v45
    v_mfma_f32_16x16x32_bf16 v[108:111], a[172:175], v[208:211], v[108:111]
    v_cvt_pk_bf16_f32 v43, v46, v47
    v_cndmask_b32_dpp v36, v32, v40, vcc row_ror:8 row_mask:0xf bank_mask:0xf
    v_mfma_f32_16x16x32_bf16 v[112:115], a[176:179], v[208:211], v[112:115]
    v_cndmask_b32_dpp v37, v33, v41, vcc row_ror:8 row_mask:0xf bank_mask:0xf
    v_cndmask_b32_dpp v38, v34, v42, vcc row_ror:8 row_mask:0xf bank_mask:0xf
    v_mfma_f32_16x16x32_bf16 v[116:119], a[180:183], v[208:211], v[116:119]
    v_cndmask_b32_dpp v39, v35, v43, vcc row_ror:8 row_mask:0xf bank_mask:0xf
    v_cvt_pk_bf16_f32 v212, v200, v201
    v_mfma_f32_16x16x32_bf16 v[120:123], a[184:187], v[208:211], v[120:123]
    ds_read_b128 a[24:27], v240 offset:9760
    v_mov_b32_dpp v32, v40 row_ror:8 row_mask:0xf bank_mask:0xc
    v_mfma_f32_16x16x32_bf16 v[124:127], a[188:191], v[208:211], v[124:127]
    s_waitcnt lgkmcnt(2)
    v_mov_b32_dpp v33, v41 row_ror:8 row_mask:0xf bank_mask:0xc
    v_mov_b32_dpp v34, v42 row_ror:8 row_mask:0xf bank_mask:0xc
    v_mfma_f32_16x16x32_bf16 v[192:195], a[0:3], a[32:35], v[224:227]
    ds_read_b128 a[28:31], v240 offset:10016
    v_mov_b32_dpp v35, v43 row_ror:8 row_mask:0xf bank_mask:0xc
    v_exp_f32 v204, v204
    v_mfma_f32_16x16x32_bf16 v[192:195], a[4:7], a[36:39], v[192:195]
    buffer_store_dwordx4 v[32:35], v242, s[28:31], s49 offen offset:0 sc1 nt
    v_exp_f32 v205, v205
    v_mfma_f32_16x16x32_bf16 v[192:195], a[8:11], a[40:43], v[192:195]
    v_cvt_pk_bf16_f32 v213, v202, v203
    v_cvt_pk_bf16_f32 v214, v204, v205
    v_mfma_f32_16x16x32_bf16 v[192:195], a[12:15], a[44:47], v[192:195]
    v_exp_f32 v206, v206
    v_mfma_f32_16x16x32_bf16 v[196:199], a[16:19], a[32:35], v[224:227]
    s_waitcnt lgkmcnt(2)
    v_exp_f32 v207, v207
    v_mfma_f32_16x16x32_bf16 v[196:199], a[20:23], a[36:39], v[196:199]
    s_waitcnt lgkmcnt(1)
    ds_read_b64_tr_b16 v[16:17], v241 offset:8224
    v_cvt_pk_bf16_f32 v215, v206, v207
    v_mfma_f32_16x16x32_bf16 v[196:199], a[24:27], a[40:43], v[196:199]
    s_waitcnt lgkmcnt(1)
    v_exp_f32 v192, v192
    v_mfma_f32_16x16x32_bf16 v[196:199], a[28:31], a[44:47], v[196:199]
    v_exp_f32 v193, v193
    v_smfmac_f32_16x16x64_bf16 a[236:239], a[252:255], v[208:215], v250
    v_exp_f32 v194, v194
    v_mfma_f32_16x16x32_bf16 v[128:131], a[160:163], v[212:215], v[128:131]
    v_exp_f32 v195, v195
    v_mfma_f32_16x16x32_bf16 v[132:135], a[164:167], v[212:215], v[132:135]
    ds_read_b64_tr_b16 v[18:19], v241 offset:9248
    v_cvt_pk_bf16_f32 v208, v192, v193
    v_mfma_f32_16x16x32_bf16 v[136:139], a[168:171], v[212:215], v[136:139]
    v_exp_f32 v196, v196
    v_mfma_f32_16x16x32_bf16 v[140:143], a[172:175], v[212:215], v[140:143]
    v_exp_f32 v197, v197
    v_mfma_f32_16x16x32_bf16 v[144:147], a[176:179], v[212:215], v[144:147]
    ds_read_b64_tr_b16 v[20:21], v241 offset:8232
    v_cvt_pk_bf16_f32 v209, v194, v195
    v_mfma_f32_16x16x32_bf16 v[148:151], a[180:183], v[212:215], v[148:151]
    buffer_store_dwordx4 v[36:39], v242, s[28:31], s49 offen offset:2048 sc1 nt
    v_mfma_f32_16x16x32_bf16 v[152:155], a[184:187], v[212:215], v[152:155]
    ds_read_b64_tr_b16 v[22:23], v241 offset:9256
    v_cvt_pk_bf16_f32 v210, v196, v197
    v_mfma_f32_16x16x32_bf16 v[156:159], a[188:191], v[212:215], v[156:159]
    ds_read_b64_tr_b16 v[24:25], v241 offset:8480
    ds_read_b64_tr_b16 v[26:27], v241 offset:9504
    v_mfma_f32_16x16x32_bf16 v[200:203], a[96:99], a[80:83], v[236:239]
    v_cvt_pk_bf16_f32 v40, v48, v49
    v_cvt_pk_bf16_f32 v41, v50, v51
    v_mfma_f32_16x16x32_bf16 v[200:203], a[100:103], a[84:87], v[200:203]
    v_cvt_pk_bf16_f32 v42, v52, v53
    v_cvt_pk_bf16_f32 v43, v54, v55
    v_mfma_f32_16x16x32_bf16 v[200:203], a[104:107], a[88:91], v[200:203]
    v_cvt_pk_bf16_f32 v56, v56, v57
    v_cvt_pk_bf16_f32 v57, v58, v59
    v_mfma_f32_16x16x32_bf16 v[200:203], a[108:111], a[92:95], v[200:203]
    v_cvt_pk_bf16_f32 v58, v60, v61
    v_cvt_pk_bf16_f32 v59, v62, v63
    v_mfma_f32_16x16x32_bf16 v[204:207], a[112:115], a[80:83], v[236:239]
    ds_read_b64_tr_b16 v[28:29], v241 offset:8488
    ds_read_b64_tr_b16 v[30:31], v241 offset:9512
    v_cndmask_b32_dpp v44, v40, v56, vcc row_ror:8 row_mask:0xf bank_mask:0xf
    v_cndmask_b32_dpp v45, v41, v57, vcc row_ror:8 row_mask:0xf bank_mask:0xf
    v_cndmask_b32_dpp v46, v42, v58, vcc row_ror:8 row_mask:0xf bank_mask:0xf
    v_cndmask_b32_dpp v47, v43, v59, vcc row_ror:8 row_mask:0xf bank_mask:0xf
    v_mov_b32_dpp v40, v56 row_ror:8 row_mask:0xf bank_mask:0xc
    v_mov_b32_dpp v41, v57 row_ror:8 row_mask:0xf bank_mask:0xc
    v_mov_b32_dpp v42, v58 row_ror:8 row_mask:0xf bank_mask:0xc
    v_mov_b32_dpp v43, v59 row_ror:8 row_mask:0xf bank_mask:0xc
    v_exp_f32 v198, v198
    v_mfma_f32_16x16x32_bf16 v[204:207], a[116:119], a[84:87], v[204:207]
    ds_read_b64_tr_b16 v[48:49], v241 offset:8736
    ds_read_b64_tr_b16 v[50:51], v241 offset:9760
    v_exp_f32 v199, v199
    v_mfma_f32_16x16x32_bf16 v[204:207], a[120:123], a[88:91], v[204:207]
    ds_read_b64_tr_b16 v[52:53], v241 offset:8744
    ds_read_b64_tr_b16 v[54:55], v241 offset:9768
    v_cvt_pk_bf16_f32 v211, v198, v199
    v_mfma_f32_16x16x32_bf16 v[204:207], a[124:127], a[92:95], v[204:207]
    s_waitcnt lgkmcnt(5)
    ds_read_b64_tr_b16 v[56:57], v241 offset:8992
    ds_read_b64_tr_b16 v[58:59], v241 offset:10016
    v_mfma_f32_16x16x32_bf16 v[64:67], v[16:19], v[208:211], v[64:67]
    ds_read_b64_tr_b16 v[60:61], v241 offset:9000
    ds_read_b64_tr_b16 v[62:63], v241 offset:10024
    v_mfma_f32_16x16x32_bf16 v[68:71], v[20:23], v[208:211], v[68:71]
    v_exp_f32 v200, v200
    v_mfma_f32_16x16x32_bf16 v[72:75], v[24:27], v[208:211], v[72:75]
    s_waitcnt lgkmcnt(8)
    v_exp_f32 v201, v201
    v_mfma_f32_16x16x32_bf16 v[76:79], v[28:31], v[208:211], v[76:79]
    s_waitcnt lgkmcnt(6)
    v_exp_f32 v202, v202
    v_mfma_f32_16x16x32_bf16 v[80:83], v[48:51], v[208:211], v[80:83]
    s_waitcnt lgkmcnt(4)
    v_exp_f32 v203, v203
    v_mfma_f32_16x16x32_bf16 v[84:87], v[52:55], v[208:211], v[84:87]
    s_waitcnt lgkmcnt(2)
    v_cvt_pk_bf16_f32 v212, v200, v201
    v_cvt_pk_bf16_f32 v213, v202, v203
    v_mfma_f32_16x16x32_bf16 v[88:91], v[56:59], v[208:211], v[88:91]
    s_waitcnt lgkmcnt(0)
    buffer_store_dwordx4 v[40:43], v242, s[28:31], s49 offen offset:128 sc1 nt
    v_mfma_f32_16x16x32_bf16 v[92:95], v[60:63], v[208:211], v[92:95]
    v_exp_f32 v204, v204
    v_mfma_f32_16x16x32_bf16 v[192:195], a[128:131], a[48:51], v[228:231]
    v_exp_f32 v205, v205
    v_mfma_f32_16x16x32_bf16 v[192:195], a[132:135], a[52:55], v[192:195]
    ds_read_b128 a[96:99], v240 offset:4112
    v_cvt_pk_bf16_f32 v214, v204, v205
    v_mfma_f32_16x16x32_bf16 v[192:195], a[136:139], a[56:59], v[192:195]
    v_exp_f32 v206, v206
    v_mfma_f32_16x16x32_bf16 v[192:195], a[140:143], a[60:63], v[192:195]
    v_exp_f32 v207, v207
    v_mfma_f32_16x16x32_bf16 v[196:199], a[144:147], a[48:51], v[228:231]
    ds_read_b128 a[100:103], v240 offset:4368
    v_cvt_pk_bf16_f32 v215, v206, v207
    v_mfma_f32_16x16x32_bf16 v[196:199], a[148:151], a[52:55], v[196:199]
    v_mfma_f32_16x16x32_bf16 v[196:199], a[152:155], a[56:59], v[196:199]
    v_exp_f32 v192, v192
    v_mfma_f32_16x16x32_bf16 v[196:199], a[156:159], a[60:63], v[196:199]
    v_exp_f32 v193, v193
    v_smfmac_f32_16x16x64_bf16 a[232:235], a[252:255], v[208:215], v250
    v_exp_f32 v194, v194
    v_mfma_f32_16x16x32_bf16 v[160:163], a[160:163], v[212:215], v[160:163]
    s_nop 5
    v_accvgpr_read_b32 v226, a232
    v_accvgpr_read_b32 v227, a233
    v_add_f32 v226, v226, v227
    v_subrev_u32 v224, 0xd800000, v226
    v_rcp_f32 v226, v226
    s_nop 0
    v_mov_b32 v227, v226
    v_pk_mul_f32 v[64:65], v[64:65], v[226:227]
    v_pk_mul_f32 v[66:67], v[66:67], v[226:227]
    v_pk_mul_f32 v[68:69], v[68:69], v[226:227]
    v_pk_mul_f32 v[70:71], v[70:71], v[226:227]
    v_pk_mul_f32 v[72:73], v[72:73], v[226:227]
    v_pk_mul_f32 v[74:75], v[74:75], v[226:227]
    v_pk_mul_f32 v[76:77], v[76:77], v[226:227]
    v_pk_mul_f32 v[78:79], v[78:79], v[226:227]
    v_pk_mul_f32 v[80:81], v[80:81], v[226:227]
    v_pk_mul_f32 v[82:83], v[82:83], v[226:227]
    v_pk_mul_f32 v[84:85], v[84:85], v[226:227]
    v_pk_mul_f32 v[86:87], v[86:87], v[226:227]
    v_pk_mul_f32 v[88:89], v[88:89], v[226:227]
    v_pk_mul_f32 v[90:91], v[90:91], v[226:227]
    v_pk_mul_f32 v[92:93], v[92:93], v[226:227]
    v_pk_mul_f32 v[94:95], v[94:95], v[226:227]
    v_mfma_f32_16x16x32_bf16 v[164:167], a[164:167], v[212:215], v[164:167]
    v_exp_f32 v195, v195
    v_mfma_f32_16x16x32_bf16 v[168:171], a[168:171], v[212:215], v[168:171]
    v_cvt_pk_bf16_f32 v208, v192, v193
    v_cvt_pk_bf16_f32 v209, v194, v195
    v_mfma_f32_16x16x32_bf16 v[172:175], a[172:175], v[212:215], v[172:175]
    v_exp_f32 v196, v196
    v_mfma_f32_16x16x32_bf16 v[176:179], a[176:179], v[212:215], v[176:179]
    buffer_store_dwordx4 v[44:47], v242, s[28:31], s49 offen offset:2176 sc1 nt
    v_mfma_f32_16x16x32_bf16 v[180:183], a[180:183], v[212:215], v[180:183]
    v_exp_f32 v197, v197
    v_mfma_f32_16x16x32_bf16 v[184:187], a[184:187], v[212:215], v[184:187]
    ds_read_b128 a[104:107], v240 offset:4624
    v_cvt_pk_bf16_f32 v210, v196, v197
    v_mfma_f32_16x16x32_bf16 v[188:191], a[188:191], v[212:215], v[188:191]
    v_exp_f32 v198, v198
    v_mfma_f32_16x16x32_bf16 v[200:203], a[0:3], a[48:51], v[228:231]
    v_exp_f32 v199, v199
    v_mfma_f32_16x16x32_bf16 v[200:203], a[4:7], a[52:55], v[200:203]
    v_cvt_pk_bf16_f32 v211, v198, v199
    v_cvt_pk_bf16_f32 v64, v64, v65
    v_mfma_f32_16x16x32_bf16 v[200:203], a[8:11], a[56:59], v[200:203]
    v_cvt_pk_bf16_f32 v65, v66, v67
    v_cvt_pk_bf16_f32 v66, v68, v69
    v_mfma_f32_16x16x32_bf16 v[200:203], a[12:15], a[60:63], v[200:203]
    ds_read_b128 a[108:111], v240 offset:4880
    v_cvt_pk_bf16_f32 v67, v70, v71
    v_mfma_f32_16x16x32_bf16 v[204:207], a[16:19], a[48:51], v[228:231]
    v_cmp_lt_u32_e64 s[40:41], s34, v224
    v_cvt_pk_bf16_f32 v68, v72, v73
    v_mfma_f32_16x16x32_bf16 v[204:207], a[20:23], a[52:55], v[204:207]
    ds_read_b128 a[112:115], v240 offset:5136
    v_cvt_pk_bf16_f32 v69, v74, v75
    v_mfma_f32_16x16x32_bf16 v[204:207], a[24:27], a[56:59], v[204:207]
    v_exp_f32 v200, v200
    v_mfma_f32_16x16x32_bf16 v[204:207], a[28:31], a[60:63], v[204:207]
    v_exp_f32 v201, v201
    v_mfma_f32_16x16x32_bf16 v[96:99], a[192:195], v[208:211], v[96:99]
    v_exp_f32 v202, v202
    v_mfma_f32_16x16x32_bf16 v[100:103], a[196:199], v[208:211], v[100:103]
    v_exp_f32 v203, v203
    v_mfma_f32_16x16x32_bf16 v[104:107], a[200:203], v[208:211], v[104:107]
    ds_read_b128 a[116:119], v240 offset:5392
    v_cvt_pk_bf16_f32 v212, v200, v201
    v_mfma_f32_16x16x32_bf16 v[108:111], a[204:207], v[208:211], v[108:111]
    v_exp_f32 v204, v204
    v_mfma_f32_16x16x32_bf16 v[112:115], a[208:211], v[208:211], v[112:115]
    buffer_store_dwordx4 v[64:67], v245, s[28:31], s50 offen offset:0 sc1 nt
    v_mfma_f32_16x16x32_bf16 v[116:119], a[212:215], v[208:211], v[116:119]
    ds_read_b128 a[120:123], v240 offset:5648
    v_cvt_pk_bf16_f32 v213, v202, v203
    v_mfma_f32_16x16x32_bf16 v[120:123], a[216:219], v[208:211], v[120:123]
    v_exp_f32 v205, v205
    v_mfma_f32_16x16x32_bf16 v[124:127], a[220:223], v[208:211], v[124:127]
    s_waitcnt lgkmcnt(2)
    ds_read_b128 a[124:127], v240 offset:5904
    v_cvt_pk_bf16_f32 v214, v204, v205
    v_mfma_f32_16x16x32_bf16 v[192:195], a[96:99], a[48:51], v[228:231]
    v_exp_f32 v206, v206
    v_mfma_f32_16x16x32_bf16 v[192:195], a[100:103], a[52:55], v[192:195]
    v_exp_f32 v207, v207
    v_mfma_f32_16x16x32_bf16 v[192:195], a[104:107], a[56:59], v[192:195]
    ds_read_b128 a[32:35], v240 offset:16448
    v_cvt_pk_bf16_f32 v215, v206, v207
    v_mfma_f32_16x16x32_bf16 v[192:195], a[108:111], a[60:63], v[192:195]
    v_cvt_pk_bf16_f32 v70, v76, v77
    v_cvt_pk_bf16_f32 v71, v78, v79
    v_mfma_f32_16x16x32_bf16 v[196:199], a[112:115], a[48:51], v[228:231]
    s_waitcnt lgkmcnt(3)
    ds_read_b128 a[36:39], v240 offset:16704
    v_cvt_pk_bf16_f32 v72, v80, v81
    v_mfma_f32_16x16x32_bf16 v[196:199], a[116:119], a[52:55], v[196:199]
    s_waitcnt lgkmcnt(3)
    ds_read_b64_tr_b16 a[160:161], v241 offset:4112
    v_cvt_pk_bf16_f32 v73, v82, v83
    v_mfma_f32_16x16x32_bf16 v[196:199], a[120:123], a[56:59], v[196:199]
    s_waitcnt lgkmcnt(3)
    v_exp_f32 v192, v192
    v_mfma_f32_16x16x32_bf16 v[196:199], a[124:127], a[60:63], v[196:199]
    v_exp_f32 v193, v193
    v_smfmac_f32_16x16x64_bf16 a[236:239], a[248:251], v[208:215], v250
    ds_read_b128 a[40:43], v240 offset:16960
    v_cvt_pk_bf16_f32 v74, v84, v85
    v_mfma_f32_16x16x32_bf16 v[96:99], v[16:19], v[212:215], v[96:99]
    v_exp_f32 v194, v194
    v_mfma_f32_16x16x32_bf16 v[100:103], v[20:23], v[212:215], v[100:103]
    ds_read_b128 a[44:47], v240 offset:17216
    v_cvt_pk_bf16_f32 v208, v192, v193
    v_mfma_f32_16x16x32_bf16 v[104:107], v[24:27], v[212:215], v[104:107]
    v_exp_f32 v195, v195
    v_mfma_f32_16x16x32_bf16 v[108:111], v[28:31], v[212:215], v[108:111]
    ds_read_b128 v[0:3], v240 offset:17472
    v_cvt_pk_bf16_f32 v209, v194, v195
    v_mfma_f32_16x16x32_bf16 v[112:115], v[48:51], v[212:215], v[112:115]
    buffer_store_dwordx4 v[68:71], v245, s[28:31], s50 offen offset:64 sc1 nt
    v_mfma_f32_16x16x32_bf16 v[116:119], v[52:55], v[212:215], v[116:119]
    ds_read_b128 v[4:7], v240 offset:17728
    v_cvt_pk_bf16_f32 v75, v86, v87
    v_mfma_f32_16x16x32_bf16 v[120:123], v[56:59], v[212:215], v[120:123]
    v_exp_f32 v196, v196
    v_mfma_f32_16x16x32_bf16 v[124:127], v[60:63], v[212:215], v[124:127]
    s_waitcnt lgkmcnt(3)
    ds_read_b128 v[8:11], v240 offset:17984
    v_cvt_pk_bf16_f32 v76, v88, v89
    v_mfma_f32_16x16x32_bf16 v[200:203], a[32:35], a[48:51], v[228:231]
    ds_read_b128 v[12:15], v240 offset:18240
    v_cvt_pk_bf16_f32 v77, v90, v91
    v_mfma_f32_16x16x32_bf16 v[200:203], a[36:39], a[52:55], v[200:203]
    ds_read_b64_tr_b16 a[162:163], v241 offset:5136
    v_exp_f32 v197, v197
    v_mfma_f32_16x16x32_bf16 v[200:203], a[40:43], a[56:59], v[200:203]
    s_waitcnt lgkmcnt(4)
    ds_read_b64_tr_b16 a[164:165], v241 offset:4120
    ds_read_b64_tr_b16 a[166:167], v241 offset:5144
    v_mfma_f32_16x16x32_bf16 v[200:203], a[44:47], a[60:63], v[200:203]
    ds_read_b64_tr_b16 a[168:169], v241 offset:4368
    ds_read_b64_tr_b16 a[170:171], v241 offset:5392
    v_cvt_pk_bf16_f32 v210, v196, v197
    v_mfma_f32_16x16x32_bf16 v[204:207], v[0:3], a[48:51], v[228:231]
    s_waitcnt lgkmcnt(7)
    ds_read_b64_tr_b16 a[172:173], v241 offset:4376
    ds_read_b64_tr_b16 a[174:175], v241 offset:5400
    v_exp_f32 v198, v198
    v_mfma_f32_16x16x32_bf16 v[204:207], v[4:7], a[52:55], v[204:207]
    s_waitcnt lgkmcnt(7)
    ds_read_b64_tr_b16 a[176:177], v241 offset:4624
    ds_read_b64_tr_b16 a[178:179], v241 offset:5648
    v_exp_f32 v199, v199
    v_mfma_f32_16x16x32_bf16 v[204:207], v[8:11], a[56:59], v[204:207]
    ds_read_b64_tr_b16 a[180:181], v241 offset:4632
    ds_read_b64_tr_b16 a[182:183], v241 offset:5656
    v_cvt_pk_bf16_f32 v211, v198, v199
    v_mfma_f32_16x16x32_bf16 v[204:207], v[12:15], a[60:63], v[204:207]
    s_waitcnt lgkmcnt(8)
    ds_read_b64_tr_b16 a[184:185], v241 offset:4880
    ds_read_b64_tr_b16 a[186:187], v241 offset:5904
    v_mfma_f32_16x16x32_bf16 v[96:99], a[160:163], v[208:211], v[96:99]
    ds_read_b64_tr_b16 a[188:189], v241 offset:4888
    ds_read_b64_tr_b16 a[190:191], v241 offset:5912
    v_mfma_f32_16x16x32_bf16 v[100:103], a[164:167], v[208:211], v[100:103]
    s_waitcnt lgkmcnt(9)
    v_exp_f32 v200, v200
    v_mfma_f32_16x16x32_bf16 v[104:107], a[168:171], v[208:211], v[104:107]
    s_waitcnt lgkmcnt(8)
    v_exp_f32 v201, v201
    v_mfma_f32_16x16x32_bf16 v[108:111], a[172:175], v[208:211], v[108:111]
    s_waitcnt lgkmcnt(6)
    v_exp_f32 v202, v202
    v_mfma_f32_16x16x32_bf16 v[112:115], a[176:179], v[208:211], v[112:115]
    s_waitcnt lgkmcnt(4)
    buffer_store_dwordx4 v[72:75], v245, s[28:31], s50 offen offset:128 sc1 nt
    v_mfma_f32_16x16x32_bf16 v[116:119], a[180:183], v[208:211], v[116:119]
    s_waitcnt lgkmcnt(2)
    v_exp_f32 v203, v203
    v_mfma_f32_16x16x32_bf16 v[120:123], a[184:187], v[208:211], v[120:123]
    s_waitcnt lgkmcnt(0)
    v_cvt_pk_bf16_f32 v212, v200, v201
    v_cvt_pk_bf16_f32 v78, v92, v93
    v_mfma_f32_16x16x32_bf16 v[124:127], a[188:191], v[208:211], v[124:127]
    v_exp_f32 v204, v204
    v_mfma_f32_16x16x32_bf16 v[192:195], a[128:131], a[64:67], v[232:235]
    v_cvt_pk_bf16_f32 v79, v94, v95
    v_cvt_pk_bf16_f32 v213, v202, v203
    v_mfma_f32_16x16x32_bf16 v[192:195], a[132:135], a[68:71], v[192:195]
    v_exp_f32 v205, v205
    v_mfma_f32_16x16x32_bf16 v[192:195], a[136:139], a[72:75], v[192:195]
    ds_read_b64_tr_b16 v[80:81], v241 offset:16448
    ds_read_b64_tr_b16 v[82:83], v241 offset:17472
    v_mfma_f32_16x16x32_bf16 v[192:195], a[140:143], a[76:79], v[192:195]
    ds_read_b64_tr_b16 v[84:85], v241 offset:16456
    ds_read_b64_tr_b16 v[86:87], v241 offset:17480
    v_cvt_pk_bf16_f32 v214, v204, v205
    v_mfma_f32_16x16x32_bf16 v[196:199], a[144:147], a[64:67], v[232:235]
    ds_read_b64_tr_b16 v[88:89], v241 offset:16704
    ds_read_b64_tr_b16 v[90:91], v241 offset:17728
    v_exp_f32 v206, v206
    v_mfma_f32_16x16x32_bf16 v[196:199], a[148:151], a[68:71], v[196:199]
    ds_read_b64_tr_b16 v[92:93], v241 offset:16712
    ds_read_b64_tr_b16 v[94:95], v241 offset:17736
    v_exp_f32 v207, v207
    v_mfma_f32_16x16x32_bf16 v[196:199], a[152:155], a[72:75], v[196:199]
    ds_read_b64_tr_b16 v[32:33], v241 offset:16960
    ds_read_b64_tr_b16 v[34:35], v241 offset:17984
    v_cvt_pk_bf16_f32 v215, v206, v207
    v_mfma_f32_16x16x32_bf16 v[196:199], a[156:159], a[76:79], v[196:199]
    ds_read_b64_tr_b16 v[36:37], v241 offset:16968
    ds_read_b64_tr_b16 v[38:39], v241 offset:17992
    v_smfmac_f32_16x16x64_bf16 a[236:239], a[248:251], v[208:215], v250
    s_waitcnt lgkmcnt(10)
    ds_read_b64_tr_b16 v[40:41], v241 offset:17216
    ds_read_b64_tr_b16 v[42:43], v241 offset:18240
    v_mfma_f32_16x16x32_bf16 v[96:99], v[80:83], v[212:215], v[96:99]
    s_waitcnt lgkmcnt(10)
    ds_read_b64_tr_b16 v[44:45], v241 offset:17224
    ds_read_b64_tr_b16 v[46:47], v241 offset:18248
    v_mfma_f32_16x16x32_bf16 v[100:103], v[84:87], v[212:215], v[100:103]
L_pad6:
    s_cbranch_execz L_warm
    s_waitcnt lgkmcnt(10)
    v_exp_f32 v192, v192
    v_mfma_f32_16x16x32_bf16 v[104:107], v[88:91], v[212:215], v[104:107]
    s_waitcnt lgkmcnt(8)
    v_exp_f32 v193, v193
    v_mfma_f32_16x16x32_bf16 v[108:111], v[92:95], v[212:215], v[108:111]
    s_waitcnt lgkmcnt(6)
    buffer_store_dwordx4 v[76:79], v245, s[28:31], s50 offen offset:192 sc1 nt
    v_mfma_f32_16x16x32_bf16 v[112:115], v[32:35], v[212:215], v[112:115]
    s_waitcnt lgkmcnt(4)
    v_exp_f32 v194, v194
    v_mfma_f32_16x16x32_bf16 v[116:119], v[36:39], v[212:215], v[116:119]
    s_waitcnt lgkmcnt(2)
    v_exp_f32 v195, v195
    v_mfma_f32_16x16x32_bf16 v[120:123], v[40:43], v[212:215], v[120:123]
    s_waitcnt lgkmcnt(0)
    v_cvt_pk_bf16_f32 v208, v192, v193
    v_cvt_pk_bf16_f32 v209, v194, v195
    v_mfma_f32_16x16x32_bf16 v[124:127], v[44:47], v[212:215], v[124:127]
    v_exp_f32 v196, v196
    v_mfma_f32_16x16x32_bf16 v[200:203], a[0:3], a[64:67], v[232:235]
    v_exp_f32 v197, v197
    v_mfma_f32_16x16x32_bf16 v[200:203], a[4:7], a[68:71], v[200:203]
    v_accvgpr_read_b32 v230, a236
    v_accvgpr_read_b32 v231, a237
    v_mfma_f32_16x16x32_bf16 v[200:203], a[8:11], a[72:75], v[200:203]
    v_cvt_pk_bf16_f32 v210, v196, v197
    v_add_f32 v230, v230, v231
    v_mfma_f32_16x16x32_bf16 v[200:203], a[12:15], a[76:79], v[200:203]
    v_exp_f32 v198, v198
    v_mfma_f32_16x16x32_bf16 v[204:207], a[16:19], a[64:67], v[232:235]
    v_subrev_u32 v228, 0xd800000, v230
    v_cmp_lt_u32_e64 s[42:43], s34, v228
    v_mfma_f32_16x16x32_bf16 v[204:207], a[20:23], a[68:71], v[204:207]
    v_exp_f32 v199, v199
    v_rcp_f32 v230, v230
    v_mfma_f32_16x16x32_bf16 v[204:207], a[24:27], a[72:75], v[204:207]
    v_cvt_pk_bf16_f32 v211, v198, v199
    v_mov_b32 v231, v230
    v_mfma_f32_16x16x32_bf16 v[204:207], a[28:31], a[76:79], v[204:207]
    v_pk_mul_f32 v[96:97], v[96:97], v[230:231]
    v_pk_mul_f32 v[98:99], v[98:99], v[230:231]
    v_pk_mul_f32 v[100:101], v[100:101], v[230:231]
    v_pk_mul_f32 v[102:103], v[102:103], v[230:231]
    v_pk_mul_f32 v[104:105], v[104:105], v[230:231]
    v_pk_mul_f32 v[106:107], v[106:107], v[230:231]
    v_pk_mul_f32 v[108:109], v[108:109], v[230:231]
    v_pk_mul_f32 v[110:111], v[110:111], v[230:231]
    v_pk_mul_f32 v[112:113], v[112:113], v[230:231]
    v_pk_mul_f32 v[114:115], v[114:115], v[230:231]
    v_pk_mul_f32 v[116:117], v[116:117], v[230:231]
    v_pk_mul_f32 v[118:119], v[118:119], v[230:231]
    v_pk_mul_f32 v[120:121], v[120:121], v[230:231]
    v_pk_mul_f32 v[122:123], v[122:123], v[230:231]
    v_pk_mul_f32 v[124:125], v[124:125], v[230:231]
    v_pk_mul_f32 v[126:127], v[126:127], v[230:231]
    v_mfma_f32_16x16x32_bf16 v[128:131], a[192:195], v[208:211], v[128:131]
    v_cvt_pk_bf16_f32 v96, v96, v97
    v_cvt_pk_bf16_f32 v97, v98, v99
    v_mfma_f32_16x16x32_bf16 v[132:135], a[196:199], v[208:211], v[132:135]
    v_cvt_pk_bf16_f32 v98, v100, v101
    v_cvt_pk_bf16_f32 v99, v102, v103
    v_mfma_f32_16x16x32_bf16 v[136:139], a[200:203], v[208:211], v[136:139]
    v_exp_f32 v200, v200
    v_mfma_f32_16x16x32_bf16 v[140:143], a[204:207], v[208:211], v[140:143]
    v_exp_f32 v201, v201
    v_mfma_f32_16x16x32_bf16 v[144:147], a[208:211], v[208:211], v[144:147]
    buffer_store_dwordx4 v[96:99], v245, s[28:31], s51 offen offset:0 sc1 nt
    v_mfma_f32_16x16x32_bf16 v[148:151], a[212:215], v[208:211], v[148:151]
    v_exp_f32 v202, v202
    v_mfma_f32_16x16x32_bf16 v[152:155], a[216:219], v[208:211], v[152:155]
    v_exp_f32 v203, v203
    v_mfma_f32_16x16x32_bf16 v[156:159], a[220:223], v[208:211], v[156:159]
    v_cvt_pk_bf16_f32 v212, v200, v201
    v_cvt_pk_bf16_f32 v213, v202, v203
    v_mfma_f32_16x16x32_bf16 v[192:195], a[96:99], a[64:67], v[232:235]
    v_exp_f32 v204, v204
    v_mfma_f32_16x16x32_bf16 v[192:195], a[100:103], a[68:71], v[192:195]
    v_exp_f32 v205, v205
    v_mfma_f32_16x16x32_bf16 v[192:195], a[104:107], a[72:75], v[192:195]
    v_cvt_pk_bf16_f32 v214, v204, v205
    v_cvt_pk_bf16_f32 v100, v104, v105
    v_mfma_f32_16x16x32_bf16 v[192:195], a[108:111], a[76:79], v[192:195]
    v_exp_f32 v206, v206
    v_mfma_f32_16x16x32_bf16 v[196:199], a[112:115], a[64:67], v[232:235]
    v_exp_f32 v207, v207
    v_mfma_f32_16x16x32_bf16 v[196:199], a[116:119], a[68:71], v[196:199]
    v_cvt_pk_bf16_f32 v215, v206, v207
    v_cvt_pk_bf16_f32 v101, v106, v107
    v_mfma_f32_16x16x32_bf16 v[196:199], a[120:123], a[72:75], v[196:199]
    v_cvt_pk_bf16_f32 v102, v108, v109
    v_cvt_pk_bf16_f32 v103, v110, v111
    v_mfma_f32_16x16x32_bf16 v[196:199], a[124:127], a[76:79], v[196:199]
    v_exp_f32 v192, v192
    v_smfmac_f32_16x16x64_bf16 a[240:243], a[248:251], v[208:215], v250
    v_exp_f32 v193, v193
    v_mfma_f32_16x16x32_bf16 v[128:131], v[16:19], v[212:215], v[128:131]
    v_exp_f32 v194, v194
    v_mfma_f32_16x16x32_bf16 v[132:135], v[20:23], v[212:215], v[132:135]
    buffer_store_dwordx4 v[100:103], v245, s[28:31], s51 offen offset:64 sc1 nt
    v_mfma_f32_16x16x32_bf16 v[136:139], v[24:27], v[212:215], v[136:139]
    v_exp_f32 v195, v195
    v_mfma_f32_16x16x32_bf16 v[140:143], v[28:31], v[212:215], v[140:143]
    v_cvt_pk_bf16_f32 v208, v192, v193
    v_cvt_pk_bf16_f32 v209, v194, v195
    v_mfma_f32_16x16x32_bf16 v[144:147], v[48:51], v[212:215], v[144:147]
    v_exp_f32 v196, v196
    v_mfma_f32_16x16x32_bf16 v[148:151], v[52:55], v[212:215], v[148:151]
    v_exp_f32 v197, v197
    v_mfma_f32_16x16x32_bf16 v[152:155], v[56:59], v[212:215], v[152:155]
    v_cvt_pk_bf16_f32 v210, v196, v197
    v_cvt_pk_bf16_f32 v104, v112, v113
    v_mfma_f32_16x16x32_bf16 v[156:159], v[60:63], v[212:215], v[156:159]
    v_exp_f32 v198, v198
    v_mfma_f32_16x16x32_bf16 v[200:203], a[32:35], a[64:67], v[232:235]
    v_exp_f32 v199, v199
    v_mfma_f32_16x16x32_bf16 v[200:203], a[36:39], a[68:71], v[200:203]
    v_cvt_pk_bf16_f32 v211, v198, v199
    v_cvt_pk_bf16_f32 v105, v114, v115
    v_mfma_f32_16x16x32_bf16 v[200:203], a[40:43], a[72:75], v[200:203]
    v_cvt_pk_bf16_f32 v106, v116, v117
    v_cvt_pk_bf16_f32 v107, v118, v119
    v_mfma_f32_16x16x32_bf16 v[200:203], a[44:47], a[76:79], v[200:203]
    v_cvt_pk_bf16_f32 v108, v120, v121
    v_cvt_pk_bf16_f32 v109, v122, v123
    v_mfma_f32_16x16x32_bf16 v[204:207], v[0:3], a[64:67], v[232:235]
    v_cvt_pk_bf16_f32 v110, v124, v125
    v_cvt_pk_bf16_f32 v111, v126, v127
    v_mfma_f32_16x16x32_bf16 v[204:207], v[4:7], a[68:71], v[204:207]
    v_mfma_f32_16x16x32_bf16 v[204:207], v[8:11], a[72:75], v[204:207]
    v_exp_f32 v200, v200
    v_mfma_f32_16x16x32_bf16 v[204:207], v[12:15], a[76:79], v[204:207]
    v_exp_f32 v201, v201
    v_mfma_f32_16x16x32_bf16 v[128:131], a[160:163], v[208:211], v[128:131]
    v_exp_f32 v202, v202
    v_mfma_f32_16x16x32_bf16 v[132:135], a[164:167], v[208:211], v[132:135]
    buffer_store_dwordx4 v[104:107], v245, s[28:31], s51 offen offset:128 sc1 nt
    v_mfma_f32_16x16x32_bf16 v[136:139], a[168:171], v[208:211], v[136:139]
    v_exp_f32 v203, v203
    v_mfma_f32_16x16x32_bf16 v[140:143], a[172:175], v[208:211], v[140:143]
    v_cvt_pk_bf16_f32 v212, v200, v201
    v_cvt_pk_bf16_f32 v213, v202, v203
    v_mfma_f32_16x16x32_bf16 v[144:147], a[176:179], v[208:211], v[144:147]
    v_exp_f32 v204, v204
    v_mfma_f32_16x16x32_bf16 v[148:151], a[180:183], v[208:211], v[148:151]
    v_exp_f32 v205, v205
    v_mfma_f32_16x16x32_bf16 v[152:155], a[184:187], v[208:211], v[152:155]
    v_cvt_pk_bf16_f32 v214, v204, v205
    v_mfma_f32_16x16x32_bf16 v[156:159], a[188:191], v[208:211], v[156:159]
    v_exp_f32 v206, v206
    v_mfma_f32_16x16x32_bf16 v[192:195], a[128:131], a[80:83], v[236:239]
    v_exp_f32 v207, v207
    v_mfma_f32_16x16x32_bf16 v[192:195], a[132:135], a[84:87], v[192:195]
    v_cvt_pk_bf16_f32 v215, v206, v207
    v_mfma_f32_16x16x32_bf16 v[192:195], a[136:139], a[88:91], v[192:195]
    v_mfma_f32_16x16x32_bf16 v[192:195], a[140:143], a[92:95], v[192:195]
    v_mfma_f32_16x16x32_bf16 v[196:199], a[144:147], a[80:83], v[236:239]
    v_mfma_f32_16x16x32_bf16 v[196:199], a[148:151], a[84:87], v[196:199]
    v_mfma_f32_16x16x32_bf16 v[196:199], a[152:155], a[88:91], v[196:199]
    v_exp_f32 v192, v192
    v_mfma_f32_16x16x32_bf16 v[196:199], a[156:159], a[92:95], v[196:199]
    v_exp_f32 v193, v193
    v_smfmac_f32_16x16x64_bf16 a[240:243], a[248:251], v[208:215], v250
    v_exp_f32 v194, v194
    v_mfma_f32_16x16x32_bf16 v[128:131], v[80:83], v[212:215], v[128:131]
    buffer_store_dwordx4 v[108:111], v245, s[28:31], s51 offen offset:192 sc1 nt
    v_mfma_f32_16x16x32_bf16 v[132:135], v[84:87], v[212:215], v[132:135]
    v_exp_f32 v195, v195
    v_mfma_f32_16x16x32_bf16 v[136:139], v[88:91], v[212:215], v[136:139]
    v_cvt_pk_bf16_f32 v208, v192, v193
    v_cvt_pk_bf16_f32 v209, v194, v195
    v_mfma_f32_16x16x32_bf16 v[140:143], v[92:95], v[212:215], v[140:143]
    v_exp_f32 v196, v196
    v_mfma_f32_16x16x32_bf16 v[144:147], v[32:35], v[212:215], v[144:147]
    v_exp_f32 v197, v197
    v_mfma_f32_16x16x32_bf16 v[148:151], v[36:39], v[212:215], v[148:151]
    v_accvgpr_read_b32 v234, a240
    v_accvgpr_read_b32 v235, a238
    v_mfma_f32_16x16x32_bf16 v[152:155], v[40:43], v[212:215], v[152:155]
    v_accvgpr_read_b32 v232, a239
    v_accvgpr_read_b32 v233, a241
    v_mfma_f32_16x16x32_bf16 v[156:159], v[44:47], v[212:215], v[156:159]
    v_cvt_pk_bf16_f32 v210, v196, v197
    v_add_f32 v234, v234, v235
    v_mfma_f32_16x16x32_bf16 v[200:203], a[0:3], a[80:83], v[236:239]
    v_add_f32 v234, v234, v232
    v_add_f32 v234, v234, v233
    v_mfma_f32_16x16x32_bf16 v[200:203], a[4:7], a[84:87], v[200:203]
    v_exp_f32 v198, v198
    v_mfma_f32_16x16x32_bf16 v[200:203], a[8:11], a[88:91], v[200:203]
    v_subrev_u32 v232, 0xd800000, v234
    v_cmp_lt_u32_e64 s[44:45], s34, v232
    v_mfma_f32_16x16x32_bf16 v[200:203], a[12:15], a[92:95], v[200:203]
    v_exp_f32 v199, v199
    v_mfma_f32_16x16x32_bf16 v[204:207], a[16:19], a[80:83], v[236:239]
    v_rcp_f32 v234, v234
    v_mfma_f32_16x16x32_bf16 v[204:207], a[20:23], a[84:87], v[204:207]
    v_cvt_pk_bf16_f32 v211, v198, v199
    v_mov_b32 v235, v234
    v_mfma_f32_16x16x32_bf16 v[204:207], a[24:27], a[88:91], v[204:207]
    v_exp_f32 v200, v200
    v_mfma_f32_16x16x32_bf16 v[204:207], a[28:31], a[92:95], v[204:207]
    v_pk_mul_f32 v[128:129], v[128:129], v[234:235]
    v_pk_mul_f32 v[130:131], v[130:131], v[234:235]
    v_pk_mul_f32 v[132:133], v[132:133], v[234:235]
    v_pk_mul_f32 v[134:135], v[134:135], v[234:235]
    v_pk_mul_f32 v[136:137], v[136:137], v[234:235]
    v_pk_mul_f32 v[138:139], v[138:139], v[234:235]
    v_pk_mul_f32 v[140:141], v[140:141], v[234:235]
    v_pk_mul_f32 v[142:143], v[142:143], v[234:235]
    v_pk_mul_f32 v[144:145], v[144:145], v[234:235]
    v_pk_mul_f32 v[146:147], v[146:147], v[234:235]
    v_pk_mul_f32 v[148:149], v[148:149], v[234:235]
    v_pk_mul_f32 v[150:151], v[150:151], v[234:235]
    v_pk_mul_f32 v[152:153], v[152:153], v[234:235]
    v_pk_mul_f32 v[154:155], v[154:155], v[234:235]
    v_pk_mul_f32 v[156:157], v[156:157], v[234:235]
    v_pk_mul_f32 v[158:159], v[158:159], v[234:235]
    v_mfma_f32_16x16x32_bf16 v[160:163], a[192:195], v[208:211], v[160:163]
    v_cvt_pk_bf16_f32 v128, v128, v129
    v_cvt_pk_bf16_f32 v129, v130, v131
    v_mfma_f32_16x16x32_bf16 v[164:167], a[196:199], v[208:211], v[164:167]
    v_cvt_pk_bf16_f32 v130, v132, v133
    v_cvt_pk_bf16_f32 v131, v134, v135
    v_mfma_f32_16x16x32_bf16 v[168:171], a[200:203], v[208:211], v[168:171]
    v_exp_f32 v201, v201
    v_mfma_f32_16x16x32_bf16 v[172:175], a[204:207], v[208:211], v[172:175]
    buffer_store_dwordx4 v[128:131], v245, s[28:31], s52 offen offset:0 sc1 nt
    v_mfma_f32_16x16x32_bf16 v[176:179], a[208:211], v[208:211], v[176:179]
    v_exp_f32 v202, v202
    v_mfma_f32_16x16x32_bf16 v[180:183], a[212:215], v[208:211], v[180:183]
    v_exp_f32 v203, v203
    v_mfma_f32_16x16x32_bf16 v[184:187], a[216:219], v[208:211], v[184:187]
    v_cvt_pk_bf16_f32 v212, v200, v201
    v_cvt_pk_bf16_f32 v213, v202, v203
    v_mfma_f32_16x16x32_bf16 v[188:191], a[220:223], v[208:211], v[188:191]
    v_exp_f32 v204, v204
    v_mfma_f32_16x16x32_bf16 v[192:195], a[96:99], a[80:83], v[236:239]
    v_exp_f32 v205, v205
    v_mfma_f32_16x16x32_bf16 v[192:195], a[100:103], a[84:87], v[192:195]
    v_cvt_pk_bf16_f32 v214, v204, v205
    v_cvt_pk_bf16_f32 v132, v136, v137
    v_mfma_f32_16x16x32_bf16 v[192:195], a[104:107], a[88:91], v[192:195]
    v_exp_f32 v206, v206
    v_mfma_f32_16x16x32_bf16 v[192:195], a[108:111], a[92:95], v[192:195]
    v_exp_f32 v207, v207
    v_mfma_f32_16x16x32_bf16 v[196:199], a[112:115], a[80:83], v[236:239]
    v_cvt_pk_bf16_f32 v215, v206, v207
    v_cvt_pk_bf16_f32 v133, v138, v139
    v_mfma_f32_16x16x32_bf16 v[196:199], a[116:119], a[84:87], v[196:199]
    v_cvt_pk_bf16_f32 v134, v140, v141
    v_cvt_pk_bf16_f32 v135, v142, v143
    v_mfma_f32_16x16x32_bf16 v[196:199], a[120:123], a[88:91], v[196:199]
    v_exp_f32 v192, v192
    v_mfma_f32_16x16x32_bf16 v[196:199], a[124:127], a[92:95], v[196:199]
    v_exp_f32 v193, v193
    v_smfmac_f32_16x16x64_bf16 a[244:247], a[248:251], v[208:215], v250
    v_exp_f32 v194, v194
    v_mfma_f32_16x16x32_bf16 v[160:163], v[16:19], v[212:215], v[160:163]
    v_exp_f32 v195, v195
    v_mfma_f32_16x16x32_bf16 v[164:167], v[20:23], v[212:215], v[164:167]
    buffer_store_dwordx4 v[132:135], v245, s[28:31], s52 offen offset:64 sc1 nt
    v_mfma_f32_16x16x32_bf16 v[168:171], v[24:27], v[212:215], v[168:171]
    v_cvt_pk_bf16_f32 v208, v192, v193
    v_cvt_pk_bf16_f32 v209, v194, v195
    v_mfma_f32_16x16x32_bf16 v[172:175], v[28:31], v[212:215], v[172:175]
    v_exp_f32 v196, v196
    v_mfma_f32_16x16x32_bf16 v[176:179], v[48:51], v[212:215], v[176:179]
    v_exp_f32 v197, v197
    v_mfma_f32_16x16x32_bf16 v[180:183], v[52:55], v[212:215], v[180:183]
    v_cvt_pk_bf16_f32 v210, v196, v197
    v_cvt_pk_bf16_f32 v136, v144, v145
    v_mfma_f32_16x16x32_bf16 v[184:187], v[56:59], v[212:215], v[184:187]
    v_exp_f32 v198, v198
    v_mfma_f32_16x16x32_bf16 v[188:191], v[60:63], v[212:215], v[188:191]
    v_exp_f32 v199, v199
    v_mfma_f32_16x16x32_bf16 v[200:203], a[32:35], a[80:83], v[236:239]
    v_cvt_pk_bf16_f32 v211, v198, v199
    v_cvt_pk_bf16_f32 v137, v146, v147
    v_mfma_f32_16x16x32_bf16 v[200:203], a[36:39], a[84:87], v[200:203]
    v_cvt_pk_bf16_f32 v138, v148, v149
    v_cvt_pk_bf16_f32 v139, v150, v151
    v_mfma_f32_16x16x32_bf16 v[200:203], a[40:43], a[88:91], v[200:203]
    v_cvt_pk_bf16_f32 v140, v152, v153
    v_cvt_pk_bf16_f32 v141, v154, v155
    v_mfma_f32_16x16x32_bf16 v[200:203], a[44:47], a[92:95], v[200:203]
    s_nop 7
    v_exp_f32 v200, v200
    v_exp_f32 v201, v201
    v_mfma_f32_16x16x32_bf16 v[204:207], v[0:3], a[80:83], v[236:239]
    v_cvt_pk_bf16_f32 v212, v200, v201
    v_cvt_pk_bf16_f32 v142, v156, v157
    v_mfma_f32_16x16x32_bf16 v[204:207], v[4:7], a[84:87], v[204:207]
    v_exp_f32 v202, v202
    v_mfma_f32_16x16x32_bf16 v[204:207], v[8:11], a[88:91], v[204:207]
    v_exp_f32 v203, v203
    v_mfma_f32_16x16x32_bf16 v[204:207], v[12:15], a[92:95], v[204:207]
    v_cvt_pk_bf16_f32 v213, v202, v203
    v_cvt_pk_bf16_f32 v143, v158, v159
    v_mfma_f32_16x16x32_bf16 v[160:163], a[160:163], v[208:211], v[160:163]
    s_nop 4
    v_exp_f32 v204, v204
    v_mfma_f32_16x16x32_bf16 v[164:167], a[164:167], v[208:211], v[164:167]
    v_exp_f32 v205, v205
    v_mfma_f32_16x16x32_bf16 v[168:171], a[168:171], v[208:211], v[168:171]
    v_cvt_pk_bf16_f32 v214, v204, v205
    v_mfma_f32_16x16x32_bf16 v[172:175], a[172:175], v[208:211], v[172:175]
    buffer_store_dwordx4 v[136:139], v245, s[28:31], s52 offen offset:128 sc1 nt
    v_mfma_f32_16x16x32_bf16 v[176:179], a[176:179], v[208:211], v[176:179]
    v_exp_f32 v206, v206
    v_mfma_f32_16x16x32_bf16 v[180:183], a[180:183], v[208:211], v[180:183]
    v_exp_f32 v207, v207
    v_mfma_f32_16x16x32_bf16 v[184:187], a[184:187], v[208:211], v[184:187]
    v_cvt_pk_bf16_f32 v215, v206, v207
    v_mfma_f32_16x16x32_bf16 v[188:191], a[188:191], v[208:211], v[188:191]
    s_nop 0
    v_smfmac_f32_16x16x64_bf16 a[244:247], a[248:251], v[208:215], v250
    v_mfma_f32_16x16x32_bf16 v[160:163], v[80:83], v[212:215], v[160:163]
    v_mfma_f32_16x16x32_bf16 v[164:167], v[84:87], v[212:215], v[164:167]
    v_mfma_f32_16x16x32_bf16 v[168:171], v[88:91], v[212:215], v[168:171]
    v_mfma_f32_16x16x32_bf16 v[172:175], v[92:95], v[212:215], v[172:175]
    s_nop 3
    v_accvgpr_read_b32 v238, a244
    v_accvgpr_read_b32 v239, a245
    v_mfma_f32_16x16x32_bf16 v[176:179], v[32:35], v[212:215], v[176:179]
    v_accvgpr_read_b32 v236, a234
    v_accvgpr_read_b32 v237, a235
    v_mfma_f32_16x16x32_bf16 v[180:183], v[36:39], v[212:215], v[180:183]
    v_add_f32 v238, v238, v239
    v_add_f32 v238, v238, v236
    v_mfma_f32_16x16x32_bf16 v[184:187], v[40:43], v[212:215], v[184:187]
    v_add_f32 v238, v238, v237
    v_subrev_u32 v236, 0xd800000, v238
    v_mfma_f32_16x16x32_bf16 v[188:191], v[44:47], v[212:215], v[188:191]
    buffer_store_dwordx4 v[140:143], v245, s[28:31], s52 offen offset:192 sc1 nt
    v_cmp_lt_u32_e64 s[46:47], s34, v236
    v_rcp_f32 v238, v238
    s_nop 0
    v_mov_b32 v239, v238
    v_pk_mul_f32 v[160:161], v[160:161], v[238:239]
    v_pk_mul_f32 v[162:163], v[162:163], v[238:239]
    v_pk_mul_f32 v[164:165], v[164:165], v[238:239]
    v_pk_mul_f32 v[166:167], v[166:167], v[238:239]
    v_cvt_pk_bf16_f32 v160, v160, v161
    v_cvt_pk_bf16_f32 v161, v162, v163
    v_cvt_pk_bf16_f32 v162, v164, v165
    v_cvt_pk_bf16_f32 v163, v166, v167
    ds_write_b128 v251, v[160:163] offset:32896
    v_pk_mul_f32 v[168:169], v[168:169], v[238:239]
    v_pk_mul_f32 v[170:171], v[170:171], v[238:239]
    v_pk_mul_f32 v[172:173], v[172:173], v[238:239]
    v_pk_mul_f32 v[174:175], v[174:175], v[238:239]
    v_cvt_pk_bf16_f32 v164, v168, v169
    v_cvt_pk_bf16_f32 v165, v170, v171
    v_cvt_pk_bf16_f32 v166, v172, v173
    v_cvt_pk_bf16_f32 v167, v174, v175
    ds_write_b128 v251, v[164:167] offset:33920
    ds_read_b128 v[160:163], v252 offset:32896
    ds_read_b128 v[164:167], v253 offset:32896
    v_pk_mul_f32 v[176:177], v[176:177], v[238:239]
    v_pk_mul_f32 v[178:179], v[178:179], v[238:239]
    v_pk_mul_f32 v[180:181], v[180:181], v[238:239]
    v_pk_mul_f32 v[182:183], v[182:183], v[238:239]
    v_cvt_pk_bf16_f32 v168, v176, v177
    v_cvt_pk_bf16_f32 v169, v178, v179
    v_cvt_pk_bf16_f32 v170, v180, v181
    v_cvt_pk_bf16_f32 v171, v182, v183
    ds_write_b128 v251, v[168:171] offset:34944
    v_pk_mul_f32 v[184:185], v[184:185], v[238:239]
    v_pk_mul_f32 v[186:187], v[186:187], v[238:239]
    v_pk_mul_f32 v[188:189], v[188:189], v[238:239]
    v_pk_mul_f32 v[190:191], v[190:191], v[238:239]
    v_cvt_pk_bf16_f32 v172, v184, v185
    v_cvt_pk_bf16_f32 v173, v186, v187
    v_cvt_pk_bf16_f32 v174, v188, v189
    v_cvt_pk_bf16_f32 v175, v190, v191
    ds_write_b128 v251, v[172:175] offset:35968
    ds_read_b128 v[168:171], v252 offset:34944
    ds_read_b128 v[172:175], v253 offset:34944
    s_waitcnt lgkmcnt(5)
    buffer_store_dwordx4 v[160:163], v254, s[28:31], s53 offen offset:0 sc1 nt
    s_waitcnt lgkmcnt(4)
    buffer_store_dwordx4 v[164:167], v254, s[28:31], s53 offen offset:2048 sc1 nt
    s_waitcnt lgkmcnt(1)
    buffer_store_dwordx4 v[168:171], v254, s[28:31], s53 offen offset:128 sc1 nt
    s_waitcnt lgkmcnt(0)
    buffer_store_dwordx4 v[172:175], v254, s[28:31], s53 offen offset:2176 sc1 nt
    s_or_b64 s[36:37], s[36:37], s[38:39]
    s_or_b64 s[40:41], s[40:41], s[42:43]
    s_or_b64 s[44:45], s[44:45], s[46:47]
    s_or_b64 s[36:37], s[36:37], s[40:41]
    s_or_b64 s[36:37], s[36:37], s[44:45]
    s_cbranch_scc1 L_slow
L_end:
    s_endpgm
L_slow:
    s_waitcnt vmcnt(0) lgkmcnt(0)
    s_barrier
    v_mbcnt_lo_u32_b32 v2, -1, 0
    v_mbcnt_hi_u32_b32 v2, -1, v2
    v_lshrrev_b32 v4, 4, v2
    v_bfe_u32 v5, v2, 2, 2
    v_and_b32 v6, 3, v2
    v_lshlrev_b32 v8, 4, v6
    v_lshl_add_u32 v8, v4, 6, v8
    v_lshl_add_u32 v244, v5, 8, v8
    v_lshlrev_b32 v9, 4, v4
    v_lshl_add_u32 v9, v6, 6, v9
    v_lshl_add_u32 v10, v5, 12, v9
    v_add_u32 v240, s13, v10
    v_lshl_add_u32 v10, v5, 10, v9
    v_add_u32 v243, s13, v10
    v_lshlrev_b32 v9, 3, v6
    v_lshl_add_u32 v9, v5, 6, v9
    v_lshl_add_u32 v9, v4, 12, v9
    v_add_u32 v241, s13, v9
    v_and_b32 v9, 1, v4
    v_lshlrev_b32 v9, 1, v9
    v_lshrrev_b32 v10, 1, v4
    v_add_u32 v9, v9, v10
    v_lshlrev_b32 v9, 4, v9
    v_and_b32 v10, 15, v2
    v_lshl_add_u32 v9, v10, 8, v9
    s_lshl_b32 s56, s12, 12
    v_add_u32 v245, s56, v9
    s_lshl_b32 s57, s12, 11
    v_mov_b32 v9, 0x3f803f80
    v_accvgpr_write_b32 a248, v9
    v_accvgpr_write_b32 a249, v9
    v_accvgpr_write_b32 a250, v9
    v_accvgpr_write_b32 a251, v9
    s_mov_b32 s48, 0
L_sb:
    s_add_u32 m0, s13, 16384
    s_add_u32 s14, s57, s48
    buffer_load_dwordx4 v244, s[16:19], s14 offen offset:0 nt lds
    buffer_load_dwordx4 v244, s[16:19], s14 offen offset:1024 nt lds
    buffer_load_dwordx4 v244, s[16:19], s14 offen offset:2048 nt lds
    buffer_load_dwordx4 v244, s[16:19], s14 offen offset:3072 nt lds
    s_waitcnt vmcnt(0)
    ds_read_b128 a[0:3], v243 offset:16384
    ds_read_b128 a[4:7], v243 offset:16640
    ds_read_b128 a[8:11], v243 offset:16896
    ds_read_b128 a[12:15], v243 offset:17152
    v_mov_b32 v246, 0xff800000
    s_mov_b32 s49, 0
L_s1:
    s_add_u32 m0, s13, 0
    s_add_u32 s14, s49, 0
    buffer_load_dwordx4 v244, s[20:23], s14 offen offset:0 lds
    buffer_load_dwordx4 v244, s[20:23], s14 offen offset:1024 lds
    s_add_u32 m0, s13, 4096
    s_add_u32 s14, s49, 2048
    buffer_load_dwordx4 v244, s[20:23], s14 offen offset:0 lds
    buffer_load_dwordx4 v244, s[20:23], s14 offen offset:1024 lds
    s_add_u32 m0, s13, 8192
    s_add_u32 s14, s49, 4096
    buffer_load_dwordx4 v244, s[20:23], s14 offen offset:0 lds
    buffer_load_dwordx4 v244, s[20:23], s14 offen offset:1024 lds
    s_add_u32 m0, s13, 12288
    s_add_u32 s14, s49, 6144
    buffer_load_dwordx4 v244, s[20:23], s14 offen offset:0 lds
    buffer_load_dwordx4 v244, s[20:23], s14 offen offset:1024 lds
    s_waitcnt vmcnt(0)
    ds_read_b128 a[96:99], v240 offset:0
    ds_read_b128 a[100:103], v240 offset:256
    ds_read_b128 a[104:107], v240 offset:512
    ds_read_b128 a[108:111], v240 offset:768
    ds_read_b128 a[112:115], v240 offset:1024
    ds_read_b128 a[116:119], v240 offset:1280
    ds_read_b128 a[120:123], v240 offset:1536
    ds_read_b128 a[124:127], v240 offset:1792
    s_waitcnt lgkmcnt(0)
    v_mfma_f32_16x16x32_bf16 v[192:195], a[96:99], a[0:3], 0
    v_mfma_f32_16x16x32_bf16 v[192:195], a[100:103], a[4:7], v[192:195]
    v_mfma_f32_16x16x32_bf16 v[192:195], a[104:107], a[8:11], v[192:195]
    v_mfma_f32_16x16x32_bf16 v[192:195], a[108:111], a[12:15], v[192:195]
    v_mfma_f32_16x16x32_bf16 v[196:199], a[112:115], a[0:3], 0
    v_mfma_f32_16x16x32_bf16 v[196:199], a[116:119], a[4:7], v[196:199]
    v_mfma_f32_16x16x32_bf16 v[196:199], a[120:123], a[8:11], v[196:199]
    v_mfma_f32_16x16x32_bf16 v[196:199], a[124:127], a[12:15], v[196:199]
    s_nop 7
    v_max3_f32 v246, v246, v192, v193
    v_max3_f32 v246, v246, v194, v195
    v_max3_f32 v246, v246, v196, v197
    v_max3_f32 v246, v246, v198, v199
    s_add_u32 s49, s49, 8192
    s_cmp_lt_u32 s49, 98304
    s_cbranch_scc1 L_s1
    v_mov_b32 v247, v246
    s_nop 1
    v_permlane16_swap_b32 v246, v247
    v_max_f32 v246, v246, v247
    v_mov_b32 v247, v246
    s_nop 1
    v_permlane32_swap_b32 v246, v247
    v_max_f32 v246, v246, v247
    v_mov_b32 v216, v246
    v_mov_b32 v0, 0
    v_mov_b32 v1, 0
    v_mov_b32 v2, 0
    v_mov_b32 v3, 0
    v_mov_b32 v4, 0
    v_mov_b32 v5, 0
    v_mov_b32 v6, 0
    v_mov_b32 v7, 0
    v_mov_b32 v8, 0
    v_mov_b32 v9, 0
    v_mov_b32 v10, 0
    v_mov_b32 v11, 0
    v_mov_b32 v12, 0
    v_mov_b32 v13, 0
    v_mov_b32 v14, 0
    v_mov_b32 v15, 0
    v_mov_b32 v16, 0
    v_mov_b32 v17, 0
    v_mov_b32 v18, 0
    v_mov_b32 v19, 0
    v_mov_b32 v20, 0
    v_mov_b32 v21, 0
    v_mov_b32 v22, 0
    v_mov_b32 v23, 0
    v_mov_b32 v24, 0
    v_mov_b32 v25, 0
    v_mov_b32 v26, 0
    v_mov_b32 v27, 0
    v_mov_b32 v28, 0
    v_mov_b32 v29, 0
    v_mov_b32 v30, 0
    v_mov_b32 v31, 0
    v_accvgpr_write_b32 a224, 0
    v_accvgpr_write_b32 a225, 0
    v_accvgpr_write_b32 a226, 0
    v_accvgpr_write_b32 a227, 0
    s_mov_b32 s49, 0
L_s2:
    s_add_u32 m0, s13, 0
    s_add_u32 s14, s49, 0
    buffer_load_dwordx4 v244, s[20:23], s14 offen offset:0 lds
    buffer_load_dwordx4 v244, s[20:23], s14 offen offset:1024 lds
    buffer_load_dwordx4 v244, s[24:27], s14 offen offset:2048 lds
    buffer_load_dwordx4 v244, s[24:27], s14 offen offset:3072 lds
    s_add_u32 m0, s13, 4096
    s_add_u32 s14, s49, 2048
    buffer_load_dwordx4 v244, s[20:23], s14 offen offset:0 lds
    buffer_load_dwordx4 v244, s[20:23], s14 offen offset:1024 lds
    buffer_load_dwordx4 v244, s[24:27], s14 offen offset:2048 lds
    buffer_load_dwordx4 v244, s[24:27], s14 offen offset:3072 lds
    s_add_u32 m0, s13, 8192
    s_add_u32 s14, s49, 4096
    buffer_load_dwordx4 v244, s[20:23], s14 offen offset:0 lds
    buffer_load_dwordx4 v244, s[20:23], s14 offen offset:1024 lds
    buffer_load_dwordx4 v244, s[24:27], s14 offen offset:2048 lds
    buffer_load_dwordx4 v244, s[24:27], s14 offen offset:3072 lds
    s_add_u32 m0, s13, 12288
    s_add_u32 s14, s49, 6144
    buffer_load_dwordx4 v244, s[20:23], s14 offen offset:0 lds
    buffer_load_dwordx4 v244, s[20:23], s14 offen offset:1024 lds
    buffer_load_dwordx4 v244, s[24:27], s14 offen offset:2048 lds
    buffer_load_dwordx4 v244, s[24:27], s14 offen offset:3072 lds
    s_waitcnt vmcnt(0)
    ds_read_b128 a[96:99], v240 offset:0
    ds_read_b128 a[100:103], v240 offset:256
    ds_read_b128 a[104:107], v240 offset:512
    ds_read_b128 a[108:111], v240 offset:768
    ds_read_b128 a[112:115], v240 offset:1024
    ds_read_b128 a[116:119], v240 offset:1280
    ds_read_b128 a[120:123], v240 offset:1536
    ds_read_b128 a[124:127], v240 offset:1792
    ds_read_b64_tr_b16 a[160:161], v241 offset:2048
    ds_read_b64_tr_b16 a[162:163], v241 offset:3072
    ds_read_b64_tr_b16 a[164:165], v241 offset:2080
    ds_read_b64_tr_b16 a[166:167], v241 offset:3104
    ds_read_b64_tr_b16 a[168:169], v241 offset:2304
    ds_read_b64_tr_b16 a[170:171], v241 offset:3328
    ds_read_b64_tr_b16 a[172:173], v241 offset:2336
    ds_read_b64_tr_b16 a[174:175], v241 offset:3360
    ds_read_b64_tr_b16 a[176:177], v241 offset:2560
    ds_read_b64_tr_b16 a[178:179], v241 offset:3584
    ds_read_b64_tr_b16 a[180:181], v241 offset:2592
    ds_read_b64_tr_b16 a[182:183], v241 offset:3616
    ds_read_b64_tr_b16 a[184:185], v241 offset:2816
    ds_read_b64_tr_b16 a[186:187], v241 offset:3840
    ds_read_b64_tr_b16 a[188:189], v241 offset:2848
    ds_read_b64_tr_b16 a[190:191], v241 offset:3872
    s_waitcnt lgkmcnt(0)
    v_mfma_f32_16x16x32_bf16 v[192:195], a[96:99], a[0:3], 0
    v_mfma_f32_16x16x32_bf16 v[192:195], a[100:103], a[4:7], v[192:195]
    v_mfma_f32_16x16x32_bf16 v[192:195], a[104:107], a[8:11], v[192:195]
    v_mfma_f32_16x16x32_bf16 v[192:195], a[108:111], a[12:15], v[192:195]
    v_mfma_f32_16x16x32_bf16 v[196:199], a[112:115], a[0:3], 0
    v_mfma_f32_16x16x32_bf16 v[196:199], a[116:119], a[4:7], v[196:199]
    v_mfma_f32_16x16x32_bf16 v[196:199], a[120:123], a[8:11], v[196:199]
    v_mfma_f32_16x16x32_bf16 v[196:199], a[124:127], a[12:15], v[196:199]
    s_nop 7
    v_sub_f32 v192, v192, v216
    v_sub_f32 v193, v193, v216
    v_sub_f32 v194, v194, v216
    v_sub_f32 v195, v195, v216
    v_sub_f32 v196, v196, v216
    v_sub_f32 v197, v197, v216
    v_sub_f32 v198, v198, v216
    v_sub_f32 v199, v199, v216
    v_mul_f32 v192, s15, v192
    v_mul_f32 v193, s15, v193
    v_mul_f32 v194, s15, v194
    v_mul_f32 v195, s15, v195
    v_mul_f32 v196, s15, v196
    v_mul_f32 v197, s15, v197
    v_mul_f32 v198, s15, v198
    v_mul_f32 v199, s15, v199
    v_exp_f32 v192, v192
    v_exp_f32 v193, v193
    v_exp_f32 v194, v194
    v_exp_f32 v195, v195
    v_exp_f32 v196, v196
    v_exp_f32 v197, v197
    v_exp_f32 v198, v198
    v_exp_f32 v199, v199
    v_cvt_pk_bf16_f32 v208, v192, v193
    v_cvt_pk_bf16_f32 v209, v194, v195
    v_cvt_pk_bf16_f32 v210, v196, v197
    v_cvt_pk_bf16_f32 v211, v198, v199
    s_nop 1
    v_mfma_f32_16x16x32_bf16 a[224:227], a[248:251], v[208:211], a[224:227]
    v_mfma_f32_16x16x32_bf16 v[0:3], a[160:163], v[208:211], v[0:3]
    v_mfma_f32_16x16x32_bf16 v[4:7], a[164:167], v[208:211], v[4:7]
    v_mfma_f32_16x16x32_bf16 v[8:11], a[168:171], v[208:211], v[8:11]
    v_mfma_f32_16x16x32_bf16 v[12:15], a[172:175], v[208:211], v[12:15]
    v_mfma_f32_16x16x32_bf16 v[16:19], a[176:179], v[208:211], v[16:19]
    v_mfma_f32_16x16x32_bf16 v[20:23], a[180:183], v[208:211], v[20:23]
    v_mfma_f32_16x16x32_bf16 v[24:27], a[184:187], v[208:211], v[24:27]
    v_mfma_f32_16x16x32_bf16 v[28:31], a[188:191], v[208:211], v[28:31]
    s_nop 7
    s_add_u32 s49, s49, 8192
    s_cmp_lt_u32 s49, 98304
    s_cbranch_scc1 L_s2
    v_accvgpr_read_b32 v246, a224
    v_rcp_f32 v246, v246
    s_nop 0
    v_mul_f32 v0, v0, v246
    v_mul_f32 v1, v1, v246
    v_mul_f32 v2, v2, v246
    v_mul_f32 v3, v3, v246
    v_mul_f32 v4, v4, v246
    v_mul_f32 v5, v5, v246
    v_mul_f32 v6, v6, v246
    v_mul_f32 v7, v7, v246
    v_mul_f32 v8, v8, v246
    v_mul_f32 v9, v9, v246
    v_mul_f32 v10, v10, v246
    v_mul_f32 v11, v11, v246
    v_mul_f32 v12, v12, v246
    v_mul_f32 v13, v13, v246
    v_mul_f32 v14, v14, v246
    v_mul_f32 v15, v15, v246
    v_mul_f32 v16, v16, v246
    v_mul_f32 v17, v17, v246
    v_mul_f32 v18, v18, v246
    v_mul_f32 v19, v19, v246
    v_mul_f32 v20, v20, v246
    v_mul_f32 v21, v21, v246
    v_mul_f32 v22, v22, v246
    v_mul_f32 v23, v23, v246
    v_mul_f32 v24, v24, v246
    v_mul_f32 v25, v25, v246
    v_mul_f32 v26, v26, v246
    v_mul_f32 v27, v27, v246
    v_mul_f32 v28, v28, v246
    v_mul_f32 v29, v29, v246
    v_mul_f32 v30, v30, v246
    v_mul_f32 v31, v31, v246
    v_cvt_pk_bf16_f32 v0, v0, v1
    v_cvt_pk_bf16_f32 v1, v2, v3
    v_cvt_pk_bf16_f32 v2, v4, v5
    v_cvt_pk_bf16_f32 v3, v6, v7
    v_cvt_pk_bf16_f32 v4, v8, v9
    v_cvt_pk_bf16_f32 v5, v10, v11
    v_cvt_pk_bf16_f32 v6, v12, v13
    v_cvt_pk_bf16_f32 v7, v14, v15
    v_cvt_pk_bf16_f32 v8, v16, v17
    v_cvt_pk_bf16_f32 v9, v18, v19
    v_cvt_pk_bf16_f32 v10, v20, v21
    v_cvt_pk_bf16_f32 v11, v22, v23
    v_cvt_pk_bf16_f32 v12, v24, v25
    v_cvt_pk_bf16_f32 v13, v26, v27
    v_cvt_pk_bf16_f32 v14, v28, v29
    v_cvt_pk_bf16_f32 v15, v30, v31
    v_permlane16_swap_b32 v0, v2
    v_permlane16_swap_b32 v1, v3
    v_permlane16_swap_b32 v4, v6
    v_permlane16_swap_b32 v5, v7
    v_permlane16_swap_b32 v8, v10
    v_permlane16_swap_b32 v9, v11
    v_permlane16_swap_b32 v12, v14
    v_permlane16_swap_b32 v13, v15
    buffer_store_dwordx4 v[0:3], v245, s[28:31], s48 offen offset:0
    buffer_store_dwordx4 v[4:7], v245, s[28:31], s48 offen offset:64
    buffer_store_dwordx4 v[8:11], v245, s[28:31], s48 offen offset:128
    buffer_store_dwordx4 v[12:15], v245, s[28:31], s48 offen offset:192
    s_waitcnt vmcnt(0)
    s_add_u32 s48, s48, 16384
    s_cmp_lt_u32 s48, 98304
    s_cbranch_scc1 L_sb
    s_endpgm
.fill (standalone__mha_softmax__near_ridge_kernel+33280-.)/4, 4, 0xbf810000
    s_endpgm
.section .rodata,"a"
.p2align 6
.amdhsa_kernel standalone__mha_softmax__near_ridge_kernel
  .amdhsa_next_free_vgpr 512
  .amdhsa_next_free_sgpr 96
  .amdhsa_accum_offset 256
  .amdhsa_group_segment_fixed_size 0
  .amdhsa_kernarg_size 48
  .amdhsa_user_sgpr_count 2
  .amdhsa_user_sgpr_kernarg_segment_ptr 1
  .amdhsa_system_sgpr_workgroup_id_x 1
.end_amdhsa_kernel
```
